```python
import torch

def _softmax(x, axis=-1):
    return torch.softmax(x, dim=axis)
def _gelu(x):
    return torch.nn.functional.gelu(x, approximate="tanh")
def _silu(x):
    return torch.nn.functional.silu(x)
def _sigmoid(x):
    return torch.sigmoid(x)
def _layernorm(x, axis=-1, eps=1e-5):
    m = x.mean(dim=axis, keepdim=True)
    v = x.var(dim=axis, keepdim=True, unbiased=False)
    return (x - m) / torch.sqrt(v + eps)
def _scatter_add(tgt, idx, src, axis=0):
    return tgt.clone().index_add_(axis, idx, src)
def _segment_sum(src, seg, n):
    out = torch.zeros((n,) + src.shape[1:], dtype=src.dtype)
    return out.index_add_(0, seg, src)
def _pad(x, pw):
    flat = tuple(v for pair in reversed(pw) for v in pair)
    return torch.nn.functional.pad(x, flat)

kernel_name = 'recurrent_scan__gqa_block_cached__dense_activation_gelu__decode'

def setup_inputs():

    _w = (lambda a: (lambda t: t.to(torch.bfloat16) if t.is_floating_point() else t)(torch.as_tensor(a)))
    def _A_setup():
        B, Sq, D = 2, 1, 512
        Hq, Hkv, Sk, Dh = 32, 8, 32768, 128
        assert Hq % Hkv == 0, (Hq, Hkv)
        return {
            "x": _w((lambda *s: torch.randn(*s, dtype=torch.bfloat16) * 0.1)(B, Sq, D)),
            "k_cache": _w((lambda *s: torch.randn(*s, dtype=torch.bfloat16) * 0.8)(B, Hkv, Sk, Dh)),
            "v_cache": _w((lambda *s: torch.randn(*s, dtype=torch.bfloat16) * 3.2)(B, Hkv, Sk, Dh)),
            "wq": _w((lambda *s: torch.randn(*s, dtype=torch.bfloat16) * 0.8)(D, Hq * Dh) * (D ** -0.5)),
            "wo": _w((lambda *s: torch.randn(*s, dtype=torch.bfloat16) * 3.2)(Hq * Dh, D) * ((Hq * Dh) ** -0.5)),
        }
    _A_in = _A_setup()

    def _B_setup():
        B, S, D, F = 2, 1, 512, 1792
        return {
            "x": _w((lambda *s: torch.randn(*s, dtype=torch.bfloat16) * 0.1)(B, S, D)),
            "w1": _w((lambda *s: torch.randn(*s, dtype=torch.bfloat16) * 3.2)(D, F) * (D ** -0.5)),
            "b1": _w((lambda *s: torch.randn(*s, dtype=torch.bfloat16) * 3.2)(F) * 0.01),
            "w2": _w((lambda *s: torch.randn(*s, dtype=torch.bfloat16) * 3.2)(F, D) * (F ** -0.5)),
            "b2": _w((lambda *s: torch.randn(*s, dtype=torch.bfloat16) * 3.2)(D) * 0.01),
        }
    _B_in = _B_setup()

    return {
        "A_x": _A_in["x"],
        "A_k_cache": _A_in["k_cache"],
        "A_v_cache": _A_in["v_cache"],
        "A_wq": _A_in["wq"],
        "A_wo": _A_in["wo"],
        "B_x": _B_in["x"],
        "B_w1": _B_in["w1"],
        "B_b1": _B_in["b1"],
        "B_w2": _B_in["w2"],
        "B_b2": _B_in["b2"],
    }

def reference(A_x, A_k_cache, A_v_cache, A_wq, A_wo, B_x, B_w1, B_b1, B_w2, B_b2):
    def _A_ref(x, k_cache, v_cache, wq, wo):
        B, Sq, D = x.shape
        Hq, Dh = 32, 128
        Hkv = k_cache.shape[1]
        rep = Hq // Hkv
        q = (lambda x, *d: x.permute(*d))((x @ wq).reshape(B, Sq, Hq, Dh), 0, 2, 1, 3)
        k = (lambda x, n, axis: torch.repeat_interleave(x, n, dim=axis))(k_cache, rep, axis=1)
        v = (lambda x, n, axis: torch.repeat_interleave(x, n, dim=axis))(v_cache, rep, axis=1)
        scores = torch.einsum("bhqd,bhkd->bhqk", q, k) * (Dh ** -0.5)
        p = _softmax(scores, axis=-1)
        o = torch.einsum("bhqk,bhkd->bhqd", p, v)
        return (lambda x, *d: x.permute(*d))(o, 0, 2, 1, 3).reshape(B, Sq, Hq * Dh) @ wo

    def _B_ref(x, w1, b1, w2, b2):
        h = torch.einsum("bsd,df->bsf", x, w1) + b1
        h = _gelu(h)
        return torch.einsum("bsf,fd->bsd", h, w2) + b2

    x = A_x
    xn = _layernorm(x, axis=-1)
    s = _A_ref(xn, A_k_cache, A_v_cache, A_wq, A_wo)
    g = _silu(_B_ref(xn, B_w1, B_b1, B_w2, B_b2))
    return x + s * g
```

```asm
; @launch grid=(256,1,1) block=(256,1,1) lds=159744
.amdgcn_target "amdgcn-amd-amdhsa--gfx950"
.text
.globl recurrent_scan__gqa_block_cached__dense_activation_gelu__decode_kernel
.p2align 8
.type recurrent_scan__gqa_block_cached__dense_activation_gelu__decode_kernel,@function
recurrent_scan__gqa_block_cached__dense_activation_gelu__decode_kernel:
  s_cmp_ge_u32 s2, 256
  s_cbranch_scc1 L_end
  s_load_dwordx16 s[24:39], s[0:1], 0
  s_load_dwordx8 s[40:47], s[0:1], 64
  s_load_dwordx2 s[48:49], s[0:1], 96
  v_lshrrev_b32 v52, 6, v0
  v_and_b32 v1, 63, v0
  v_readfirstlane_b32 s3, v52
  s_lshr_b32 s58, s2, 4
  s_and_b32 s59, s2, 15
  s_lshr_b32 s50, s58, 3
  s_and_b32 s51, s58, 7
  s_lshl_b32 s52, s50, 4
  s_add_u32 s52, s52, s59
  s_lshl_b32 s54, s58, 23
  s_mul_i32 s76, s58, 77
  s_lshl_b32 s57, s58, 8
  s_add_u32 s57, s57, 4096
  s_lshl_b32 s61, s59, 2
  s_add_u32 s61, s61, s3
  s_lshl_b32 s53, s3, 15
  v_lshrrev_b32 v27, 4, v1
  v_and_b32 v28, 15, v1
  v_xor_b32 v52, v28, v27
  v_lshlrev_b32 v52, 4, v52
  v_lshl_add_u32 v2, v27, 8, v52
  v_xor_b32 v3, 64, v2
  v_xor_b32 v4, 128, v2
  v_xor_b32 v5, 192, v2
  v_lshlrev_b32 v53, 1, v27
  v_xor_b32 v53, v28, v53
  v_lshlrev_b32 v53, 4, v53
  v_lshl_add_u32 v6, v27, 8, v53
  v_xor_b32 v7, 128, v6
  v_lshrrev_b32 v29, 3, v1
  v_and_b32 v30, 7, v1
  v_mov_b32 v23, 0
  v_lshlrev_b32 v34, 4, v1
  v_and_b32 v54, 6, v29
  v_xor_b32 v54, v54, v30
  v_lshlrev_b32 v209, 4, v54
  v_lshl_add_u32 v208, v29, 13, v209
  s_lshr_b32 s58, s2, 3
  s_add_u32 s59, s58, 4
  s_xor_b32 s59, s59, s2
  s_and_b32 s59, s59, 7
  s_cmp_eq_u32 s59, 0
  s_cselect_b32 s66, s58, 255
  s_lshr_b32 s58, s52, 3
  s_lshl_b32 s58, s58, 2
  s_add_u32 s58, s58, s3
  s_lshl_b32 s58, s58, 18
  s_and_b32 s59, s52, 7
  s_lshl_b32 s59, s59, 7
  s_lshl_b32 s60, s51, 10
  s_add_u32 s58, s58, s59
  s_add_u32 s69, s58, s60
  s_mov_b32 s67, 0
  s_waitcnt lgkmcnt(0)
  s_mov_b32 s12, s48
  s_and_b32 s13, s49, 0xffff
  s_mov_b32 s14, 4194304
  s_mov_b32 s15, 0x20000
  s_mov_b32 s16, s24
  s_and_b32 s17, s25, 0xffff
  s_mov_b32 s18, 2048
  s_mov_b32 s19, 0x20000
  s_mov_b32 s20, s30
  s_and_b32 s21, s31, 0xffff
  s_mov_b32 s22, 4194304
  s_mov_b32 s23, 0x20000
  s_mov_b32 s4, s26
  s_and_b32 s5, s27, 0xffff
  s_mov_b32 s6, 134217728
  s_mov_b32 s7, 0x20000
  s_mov_b32 s8, s28
  s_and_b32 s9, s29, 0xffff
  s_mov_b32 s10, 134217728
  s_mov_b32 s11, 0x20000
  s_cmp_lg_u32 s61, 0
  s_cbranch_scc1 L_notleader_1
  s_mov_b64 exec, 1
  buffer_store_dword v23, v23, s[12:15], s57 offen sc1
  s_mov_b64 exec, -1
L_notleader_1:
  buffer_load_dwordx4 v[212:215], v34, s[16:19], 0 offen
  buffer_load_dwordx4 v[216:219], v34, s[16:19], 0 offen offset:1024
  buffer_load_dword v210, v23, s[12:15], 0 offen sc1
  s_lshl_b32 s59, s3, 12
  s_add_u32 m0, s59, 131072
  s_nop 0
  buffer_load_dwordx4 v208, s[20:23], s69 offen offset:0 nt lds
  s_add_u32 s69, s69, 64512
  buffer_load_dwordx4 v208, s[20:23], s69 offen offset:1024 nt lds
  s_add_u32 s69, s69, 64512
  buffer_load_dwordx4 v208, s[20:23], s69 offen offset:2048 nt lds
  s_add_u32 s69, s69, 64512
  buffer_load_dwordx4 v208, s[20:23], s69 offen offset:3072 nt lds
  s_cmp_lt_u32 s66, 28
  s_cbranch_scc1 L_ffn_pre_2
  s_add_u32 s56, s61, s76
  s_and_b32 s56, s56, 1023
  s_lshl_b32 s56, s56, 13
  s_add_u32 m0, s53, 0
  s_add_u32 s56, s56, s54
  buffer_load_dwordx4 v2, s[4:7], s56 offen offset:0 nt lds
  buffer_load_dwordx4 v3, s[4:7], s56 offen offset:1024 nt lds
  buffer_load_dwordx4 v4, s[4:7], s56 offen offset:2048 nt lds
  buffer_load_dwordx4 v5, s[4:7], s56 offen offset:3072 nt lds
  s_add_u32 m0, s53, 4096
  s_add_u32 s56, s56, 4096
  buffer_load_dwordx4 v2, s[4:7], s56 offen offset:0 nt lds
  buffer_load_dwordx4 v3, s[4:7], s56 offen offset:1024 nt lds
  buffer_load_dwordx4 v4, s[4:7], s56 offen offset:2048 nt lds
  buffer_load_dwordx4 v5, s[4:7], s56 offen offset:3072 nt lds
  s_branch L_pre_done_3
L_ffn_pre_2:
  s_mov_b32 s20, s36
  s_and_b32 s21, s37, 0xffff
  s_mov_b32 s22, 1835008
  s_mov_b32 s23, 0x20000
  s_mov_b32 s58, 3584
  v_mul_lo_u32 v52, v29, s58
  v_add_u32 v52, v52, v209
  s_mul_i32 s58, s3, 458752
  s_lshl_b32 s59, s66, 7
  s_add_u32 s58, s58, s59
  s_lshl_b32 s60, s3, 14
  s_add_u32 m0, s60, 0
  s_nop 0
  buffer_load_dwordx4 v52, s[20:23], s58 offen offset:0 nt lds
  s_add_u32 s58, s58, 27648
  buffer_load_dwordx4 v52, s[20:23], s58 offen offset:1024 nt lds
  s_add_u32 s58, s58, 27648
  buffer_load_dwordx4 v52, s[20:23], s58 offen offset:2048 nt lds
  s_add_u32 s58, s58, 27648
  buffer_load_dwordx4 v52, s[20:23], s58 offen offset:3072 nt lds
  s_add_u32 s58, s58, 31744
  s_add_u32 m0, s60, 4096
  s_nop 0
  buffer_load_dwordx4 v52, s[20:23], s58 offen offset:0 nt lds
  s_add_u32 s58, s58, 27648
  buffer_load_dwordx4 v52, s[20:23], s58 offen offset:1024 nt lds
  s_add_u32 s58, s58, 27648
  buffer_load_dwordx4 v52, s[20:23], s58 offen offset:2048 nt lds
  s_add_u32 s58, s58, 27648
  buffer_load_dwordx4 v52, s[20:23], s58 offen offset:3072 nt lds
  s_add_u32 s58, s58, 31744
  s_add_u32 m0, s60, 8192
  s_nop 0
  buffer_load_dwordx4 v52, s[20:23], s58 offen offset:0 nt lds
  s_add_u32 s58, s58, 27648
  buffer_load_dwordx4 v52, s[20:23], s58 offen offset:1024 nt lds
  s_add_u32 s58, s58, 27648
  buffer_load_dwordx4 v52, s[20:23], s58 offen offset:2048 nt lds
  s_add_u32 s58, s58, 27648
  buffer_load_dwordx4 v52, s[20:23], s58 offen offset:3072 nt lds
  s_add_u32 s58, s58, 31744
  s_add_u32 m0, s60, 12288
  s_nop 0
  buffer_load_dwordx4 v52, s[20:23], s58 offen offset:0 nt lds
  s_add_u32 s58, s58, 27648
  buffer_load_dwordx4 v52, s[20:23], s58 offen offset:1024 nt lds
  s_add_u32 s58, s58, 27648
  buffer_load_dwordx4 v52, s[20:23], s58 offen offset:2048 nt lds
  s_add_u32 s58, s58, 27648
  buffer_load_dwordx4 v52, s[20:23], s58 offen offset:3072 nt lds
  s_add_u32 s58, s58, 31744
L_pre_done_3:
  v_xor_b32 v52, v28, v27
  v_lshlrev_b32 v52, 4, v52
  v_lshl_add_u32 v52, v28, 8, v52
  v_xor_b32 v8, 0, v52
  v_add_u32 v8, s53, v8
  v_xor_b32 v9, 64, v52
  v_add_u32 v9, s53, v9
  v_xor_b32 v10, 128, v52
  v_add_u32 v10, s53, v10
  v_xor_b32 v11, 192, v52
  v_add_u32 v11, s53, v11
  v_lshrrev_b32 v31, 2, v28
  v_and_b32 v32, 3, v1
  v_lshl_add_u32 v52, v27, 2, v31
  v_and_b32 v53, 7, v52
  v_lshlrev_b32 v53, 5, v53
  v_lshl_add_u32 v53, v52, 8, v53
  v_lshl_add_u32 v33, v32, 3, v53
  v_xor_b32 v12, 0, v33
  v_add_u32 v12, s53, v12
  v_xor_b32 v13, 32, v33
  v_add_u32 v13, s53, v13
  v_xor_b32 v14, 64, v33
  v_add_u32 v14, s53, v14
  v_xor_b32 v15, 96, v33
  v_add_u32 v15, s53, v15
  v_xor_b32 v16, 128, v33
  v_add_u32 v16, s53, v16
  v_xor_b32 v17, 160, v33
  v_add_u32 v17, s53, v17
  v_xor_b32 v18, 192, v33
  v_add_u32 v18, s53, v18
  v_xor_b32 v19, 224, v33
  v_add_u32 v19, s53, v19
  s_mov_b32 s64, 0x3fb8aa3b
  s_mov_b32 s77, 0x3db504f3
  v_mov_b32 v21, 0xfffffc00
  v_lshl_add_u32 v52, v27, 2, v31
  v_lshrrev_b32 v53, 1, v52
  v_and_b32 v53, 3, v53
  v_xor_b32 v53, s3, v53
  v_lshlrev_b32 v53, 5, v53
  v_lshl_add_u32 v53, v52, 7, v53
  v_lshl_add_u32 v220, v32, 3, v53
  v_add_u32 v220, 131072, v220
  s_lshr_b32 s59, s52, 3
  s_lshl_b32 s59, s59, 7
  v_and_b32 v52, 1, v1
  v_lshlrev_b32 v52, 10, v52
  v_lshl_add_u32 v52, v27, 3, v52
  v_add_u32 v221, 155904, v52
  s_lshl_b32 s58, s59, 1
  v_add_u32 v221, s58, v221
  s_lshl_b32 s58, s51, 14
  s_and_b32 s59, s52, 7
  s_lshl_b32 s59, s59, 10
  s_add_u32 s58, s58, s59
  s_lshr_b32 s59, s52, 3
  s_lshl_b32 s59, s59, 8
  s_add_u32 s58, s58, s59
  s_lshl_b32 s59, s3, 6
  s_add_u32 s58, s58, s59
  s_add_u32 s69, s58, 65536
  v_lshlrev_b32 v222, 13, v28
  v_lshl_add_u32 v222, v27, 4, v222
  s_cmp_lt_u32 s66, 28
  s_cbranch_scc1 L_xf_4
  s_waitcnt vmcnt(13)
  s_branch L_xj_5
L_xf_4:
  s_waitcnt vmcnt(21)
L_xj_5:
  v_lshlrev_b32 v96, 16, v212
  v_and_b32 v97, 0xffff0000, v212
  v_lshlrev_b32 v98, 16, v213
  v_and_b32 v99, 0xffff0000, v213
  v_lshlrev_b32 v100, 16, v214
  v_and_b32 v101, 0xffff0000, v214
  v_lshlrev_b32 v102, 16, v215
  v_and_b32 v103, 0xffff0000, v215
  v_lshlrev_b32 v104, 16, v216
  v_and_b32 v105, 0xffff0000, v216
  v_lshlrev_b32 v106, 16, v217
  v_and_b32 v107, 0xffff0000, v217
  v_lshlrev_b32 v108, 16, v218
  v_and_b32 v109, 0xffff0000, v218
  v_lshlrev_b32 v110, 16, v219
  v_and_b32 v111, 0xffff0000, v219
  v_add_f32 v52, v96, v97
  v_add_f32 v53, v104, v105
  v_add_f32 v52, v52, v98
  v_add_f32 v53, v53, v106
  v_add_f32 v52, v52, v99
  v_add_f32 v53, v53, v107
  v_add_f32 v52, v52, v100
  v_add_f32 v53, v53, v108
  v_add_f32 v52, v52, v101
  v_add_f32 v53, v53, v109
  v_add_f32 v52, v52, v102
  v_add_f32 v53, v53, v110
  v_add_f32 v52, v52, v103
  v_add_f32 v53, v53, v111
  s_nop 0
  v_add_f32 v52, v52, v52 quad_perm:[1,0,3,2] row_mask:0xf bank_mask:0xf
  v_add_f32 v53, v53, v53 quad_perm:[1,0,3,2] row_mask:0xf bank_mask:0xf
  s_nop 0
  v_add_f32 v52, v52, v52 quad_perm:[2,3,0,1] row_mask:0xf bank_mask:0xf
  v_add_f32 v53, v53, v53 quad_perm:[2,3,0,1] row_mask:0xf bank_mask:0xf
  s_nop 0
  v_add_f32 v52, v52, v52 row_half_mirror row_mask:0xf bank_mask:0xf
  v_add_f32 v53, v53, v53 row_half_mirror row_mask:0xf bank_mask:0xf
  s_nop 0
  v_add_f32 v52, v52, v52 row_mirror row_mask:0xf bank_mask:0xf
  v_add_f32 v53, v53, v53 row_mirror row_mask:0xf bank_mask:0xf
  v_mov_b32 v54, v52
  v_mov_b32 v55, v53
  s_nop 0
  v_permlane16_swap_b32 v52, v54
  v_permlane16_swap_b32 v53, v55
  v_add_f32 v52, v52, v54
  v_add_f32 v53, v53, v55
  v_mov_b32 v54, v52
  v_mov_b32 v55, v53
  s_nop 0
  v_permlane32_swap_b32 v52, v54
  v_permlane32_swap_b32 v53, v55
  v_add_f32 v52, v52, v54
  v_add_f32 v53, v53, v55
  v_mul_f32 v52, 0x3b000000, v52
  v_mul_f32 v53, 0x3b000000, v53
  v_sub_f32 v58, v96, v52
  v_mul_f32 v56, v58, v58
  v_sub_f32 v59, v104, v53
  v_mul_f32 v57, v59, v59
  v_sub_f32 v58, v97, v52
  v_fmac_f32 v56, v58, v58
  v_sub_f32 v59, v105, v53
  v_fmac_f32 v57, v59, v59
  v_sub_f32 v58, v98, v52
  v_fmac_f32 v56, v58, v58
  v_sub_f32 v59, v106, v53
  v_fmac_f32 v57, v59, v59
  v_sub_f32 v58, v99, v52
  v_fmac_f32 v56, v58, v58
  v_sub_f32 v59, v107, v53
  v_fmac_f32 v57, v59, v59
  v_sub_f32 v58, v100, v52
  v_fmac_f32 v56, v58, v58
  v_sub_f32 v59, v108, v53
  v_fmac_f32 v57, v59, v59
  v_sub_f32 v58, v101, v52
  v_fmac_f32 v56, v58, v58
  v_sub_f32 v59, v109, v53
  v_fmac_f32 v57, v59, v59
  v_sub_f32 v58, v102, v52
  v_fmac_f32 v56, v58, v58
  v_sub_f32 v59, v110, v53
  v_fmac_f32 v57, v59, v59
  v_sub_f32 v58, v103, v52
  v_fmac_f32 v56, v58, v58
  v_sub_f32 v59, v111, v53
  v_fmac_f32 v57, v59, v59
  v_add_f32 v56, v56, v56 quad_perm:[1,0,3,2] row_mask:0xf bank_mask:0xf
  s_nop 0
  v_add_f32 v57, v57, v57 quad_perm:[1,0,3,2] row_mask:0xf bank_mask:0xf
  v_add_f32 v56, v56, v56 quad_perm:[2,3,0,1] row_mask:0xf bank_mask:0xf
  s_nop 0
  v_add_f32 v57, v57, v57 quad_perm:[2,3,0,1] row_mask:0xf bank_mask:0xf
  v_add_f32 v56, v56, v56 row_half_mirror row_mask:0xf bank_mask:0xf
  s_nop 0
  v_add_f32 v57, v57, v57 row_half_mirror row_mask:0xf bank_mask:0xf
  v_add_f32 v56, v56, v56 row_mirror row_mask:0xf bank_mask:0xf
  s_nop 0
  v_add_f32 v57, v57, v57 row_mirror row_mask:0xf bank_mask:0xf
  v_mov_b32 v54, v56
  v_mov_b32 v55, v57
  s_nop 0
  v_permlane16_swap_b32 v56, v54
  v_permlane16_swap_b32 v57, v55
  v_add_f32 v56, v56, v54
  v_add_f32 v57, v57, v55
  v_mov_b32 v54, v56
  v_mov_b32 v55, v57
  s_nop 0
  v_permlane32_swap_b32 v56, v54
  v_permlane32_swap_b32 v57, v55
  v_add_f32 v56, v56, v54
  v_add_f32 v57, v57, v55
  v_mul_f32 v56, 0x3b000000, v56
  v_mul_f32 v57, 0x3b000000, v57
  v_cvt_pk_bf16_f32 v56, v56, v56
  v_cvt_pk_bf16_f32 v57, v57, v57
  v_and_b32 v56, 0xffff0000, v56
  v_and_b32 v57, 0xffff0000, v57
  v_add_f32 v56, 0x3727c5ac, v56
  v_add_f32 v57, 0x3727c5ac, v57
  v_cvt_pk_bf16_f32 v56, v56, v56
  v_cvt_pk_bf16_f32 v57, v57, v57
  v_and_b32 v56, 0xffff0000, v56
  v_and_b32 v57, 0xffff0000, v57
  v_sqrt_f32 v56, v56
  v_sqrt_f32 v57, v57
  v_cvt_pk_bf16_f32 v52, v52, v52
  v_cvt_pk_bf16_f32 v53, v53, v53
  v_cvt_pk_bf16_f32 v56, v56, v56
  v_cvt_pk_bf16_f32 v57, v57, v57
  v_and_b32 v52, 0xffff0000, v52
  v_and_b32 v53, 0xffff0000, v53
  v_and_b32 v56, 0xffff0000, v56
  v_and_b32 v57, 0xffff0000, v57
  v_rcp_f32 v56, v56
  v_rcp_f32 v57, v57
  v_sub_f32 v96, v96, v52
  v_sub_f32 v97, v97, v52
  v_sub_f32 v98, v98, v52
  v_sub_f32 v99, v99, v52
  v_sub_f32 v100, v100, v52
  v_sub_f32 v101, v101, v52
  v_sub_f32 v102, v102, v52
  v_sub_f32 v103, v103, v52
  v_sub_f32 v104, v104, v53
  v_sub_f32 v105, v105, v53
  v_sub_f32 v106, v106, v53
  v_sub_f32 v107, v107, v53
  v_sub_f32 v108, v108, v53
  v_sub_f32 v109, v109, v53
  v_sub_f32 v110, v110, v53
  v_sub_f32 v111, v111, v53
  v_cvt_pk_bf16_f32 v212, v96, v97
  v_cvt_pk_bf16_f32 v213, v98, v99
  v_cvt_pk_bf16_f32 v214, v100, v101
  v_cvt_pk_bf16_f32 v215, v102, v103
  v_cvt_pk_bf16_f32 v216, v104, v105
  v_cvt_pk_bf16_f32 v217, v106, v107
  v_cvt_pk_bf16_f32 v218, v108, v109
  v_cvt_pk_bf16_f32 v219, v110, v111
  v_lshlrev_b32 v96, 16, v212
  v_and_b32 v97, 0xffff0000, v212
  v_lshlrev_b32 v98, 16, v213
  v_and_b32 v99, 0xffff0000, v213
  v_lshlrev_b32 v100, 16, v214
  v_and_b32 v101, 0xffff0000, v214
  v_lshlrev_b32 v102, 16, v215
  v_and_b32 v103, 0xffff0000, v215
  v_lshlrev_b32 v104, 16, v216
  v_and_b32 v105, 0xffff0000, v216
  v_lshlrev_b32 v106, 16, v217
  v_and_b32 v107, 0xffff0000, v217
  v_lshlrev_b32 v108, 16, v218
  v_and_b32 v109, 0xffff0000, v218
  v_lshlrev_b32 v110, 16, v219
  v_and_b32 v111, 0xffff0000, v219
  v_mul_f32 v96, v96, v56
  v_mul_f32 v97, v97, v56
  v_mul_f32 v98, v98, v56
  v_mul_f32 v99, v99, v56
  v_mul_f32 v100, v100, v56
  v_mul_f32 v101, v101, v56
  v_mul_f32 v102, v102, v56
  v_mul_f32 v103, v103, v56
  v_mul_f32 v104, v104, v57
  v_mul_f32 v105, v105, v57
  v_mul_f32 v106, v106, v57
  v_mul_f32 v107, v107, v57
  v_mul_f32 v108, v108, v57
  v_mul_f32 v109, v109, v57
  v_mul_f32 v110, v110, v57
  v_mul_f32 v111, v111, v57
  v_cvt_pk_bf16_f32 v212, v96, v97
  v_cvt_pk_bf16_f32 v213, v98, v99
  v_cvt_pk_bf16_f32 v214, v100, v101
  v_cvt_pk_bf16_f32 v215, v102, v103
  v_cvt_pk_bf16_f32 v216, v104, v105
  v_cvt_pk_bf16_f32 v217, v106, v107
  v_cvt_pk_bf16_f32 v218, v108, v109
  v_cvt_pk_bf16_f32 v219, v110, v111
  v_add_u32 v52, 155904, v34
  ds_write_b128 v52, v[212:215]
  ds_write_b128 v52, v[216:219] offset:1024
  s_cmp_lt_u32 s66, 28
  s_cbranch_scc1 L_wqf_6
  s_waitcnt vmcnt(8)
  s_add_u32 s56, s61, s76
  s_and_b32 s56, s56, 1023
  s_lshl_b32 s56, s56, 13
  s_add_u32 m0, s53, 8192
  s_add_u32 s56, s56, s54
  buffer_load_dwordx4 v6, s[8:11], s56 offen offset:0 nt lds
  buffer_load_dwordx4 v7, s[8:11], s56 offen offset:1024 nt lds
  buffer_load_dwordx4 v6, s[8:11], s56 offen offset:2048 nt lds
  buffer_load_dwordx4 v7, s[8:11], s56 offen offset:3072 nt lds
  s_add_u32 m0, s53, 12288
  s_add_u32 s56, s56, 4096
  buffer_load_dwordx4 v6, s[8:11], s56 offen offset:0 nt lds
  buffer_load_dwordx4 v7, s[8:11], s56 offen offset:1024 nt lds
  buffer_load_dwordx4 v6, s[8:11], s56 offen offset:2048 nt lds
  buffer_load_dwordx4 v7, s[8:11], s56 offen offset:3072 nt lds
  s_branch L_wqj_7
L_wqf_6:
  s_waitcnt vmcnt(16)
L_wqj_7:
  v_add_u32 v20, 1, v210
  v_and_b32 v20, 1023, v20
  s_waitcnt lgkmcnt(0)
  s_barrier
  ds_read_b64_tr_b16 v[96:97], v220 offset:0
  ds_read_b64 v[128:129], v221 offset:0
  ds_read_b64_tr_b16 v[98:99], v220 offset:2048
  ds_read_b64 v[130:131], v221 offset:32
  ds_read_b64_tr_b16 v[100:101], v220 offset:4096
  ds_read_b64 v[132:133], v221 offset:64
  ds_read_b64_tr_b16 v[102:103], v220 offset:6144
  ds_read_b64 v[134:135], v221 offset:96
  ds_read_b64_tr_b16 v[104:105], v220 offset:8192
  ds_read_b64 v[136:137], v221 offset:128
  ds_read_b64_tr_b16 v[106:107], v220 offset:10240
  ds_read_b64 v[138:139], v221 offset:160
  s_waitcnt lgkmcnt(8)
  ds_read_b64_tr_b16 v[108:109], v220 offset:12288
  ds_read_b64 v[140:141], v221 offset:192
  ds_read_b64_tr_b16 v[110:111], v220 offset:14336
  ds_read_b64 v[142:143], v221 offset:224
  s_waitcnt lgkmcnt(8)
  v_mfma_f32_16x16x32_bf16 v[84:87], v[96:99], v[128:131], 0
  s_waitcnt lgkmcnt(8)
  v_mfma_f32_16x16x32_bf16 v[84:87], v[100:103], v[132:135], v[84:87]
  s_waitcnt lgkmcnt(4)
  v_mfma_f32_16x16x32_bf16 v[84:87], v[104:107], v[136:139], v[84:87]
  s_waitcnt lgkmcnt(0)
  v_mfma_f32_16x16x32_bf16 v[84:87], v[108:111], v[140:143], v[84:87]
  v_cmp_gt_u32 vcc, 2, v28
  s_nop 0
  s_and_saveexec_b64 s[62:63], vcc
  s_nop 4
  v_bfi_b32 v56, v21, v84, v20
  v_bfi_b32 v57, v21, v85, v20
  v_bfi_b32 v58, v21, v86, v20
  v_bfi_b32 v59, v21, v87, v20
  buffer_store_dwordx4 v[56:59], v222, s[12:15], s69 offen sc1
  s_mov_b64 exec, s[62:63]
  s_cmp_ge_u32 s66, 28
  s_cbranch_scc1 L_noffn_8
  s_mov_b32 s16, s38
  s_and_b32 s17, s39, 0xffff
  s_mov_b32 s18, 3584
  s_mov_b32 s19, 0x20000
  s_lshl_b32 s58, s66, 7
  s_lshl_b32 s59, s3, 5
  s_add_u32 s58, s58, s59
  v_lshlrev_b32 v52, 3, v27
  buffer_load_dwordx2 v[236:237], v52, s[16:19], s58 offen
  s_mov_b32 s20, s40
  s_and_b32 s21, s41, 0xffff
  s_mov_b32 s22, 1835008
  s_mov_b32 s23, 0x20000
  v_lshlrev_b32 v53, 1, v27
  v_xor_b32 v53, v28, v53
  v_lshlrev_b32 v53, 4, v53
  v_lshl_add_u32 v53, v27, 10, v53
  v_xor_b32 v54, 128, v53
  s_lshl_b32 s58, s66, 16
  s_lshl_b32 s59, s3, 8
  s_add_u32 s58, s58, s59
  s_lshl_b32 s60, s3, 14
  s_add_u32 s60, s60, 65536
  s_add_u32 m0, s60, 0
  s_nop 0
  buffer_load_dwordx4 v53, s[20:23], s58 offen offset:0 nt lds
  s_add_u32 s58, s58, 3072
  buffer_load_dwordx4 v54, s[20:23], s58 offen offset:1024 nt lds
  s_add_u32 s58, s58, 3072
  buffer_load_dwordx4 v53, s[20:23], s58 offen offset:2048 nt lds
  s_add_u32 s58, s58, 3072
  buffer_load_dwordx4 v54, s[20:23], s58 offen offset:3072 nt lds
  s_add_u32 s58, s58, 7168
  s_add_u32 m0, s60, 4096
  s_nop 0
  buffer_load_dwordx4 v53, s[20:23], s58 offen offset:0 nt lds
  s_add_u32 s58, s58, 3072
  buffer_load_dwordx4 v54, s[20:23], s58 offen offset:1024 nt lds
  s_add_u32 s58, s58, 3072
  buffer_load_dwordx4 v53, s[20:23], s58 offen offset:2048 nt lds
  s_add_u32 s58, s58, 3072
  buffer_load_dwordx4 v54, s[20:23], s58 offen offset:3072 nt lds
  s_add_u32 s58, s58, 7168
  s_add_u32 m0, s60, 8192
  s_nop 0
  buffer_load_dwordx4 v53, s[20:23], s58 offen offset:0 nt lds
  s_add_u32 s58, s58, 3072
  buffer_load_dwordx4 v54, s[20:23], s58 offen offset:1024 nt lds
  s_add_u32 s58, s58, 3072
  buffer_load_dwordx4 v53, s[20:23], s58 offen offset:2048 nt lds
  s_add_u32 s58, s58, 3072
  buffer_load_dwordx4 v54, s[20:23], s58 offen offset:3072 nt lds
  s_add_u32 s58, s58, 7168
  s_add_u32 m0, s60, 12288
  s_nop 0
  buffer_load_dwordx4 v53, s[20:23], s58 offen offset:0 nt lds
  s_add_u32 s58, s58, 3072
  buffer_load_dwordx4 v54, s[20:23], s58 offen offset:1024 nt lds
  s_add_u32 s58, s58, 3072
  buffer_load_dwordx4 v53, s[20:23], s58 offen offset:2048 nt lds
  s_add_u32 s58, s58, 3072
  buffer_load_dwordx4 v54, s[20:23], s58 offen offset:3072 nt lds
  s_add_u32 s58, s58, 7168
  s_waitcnt vmcnt(18)
  s_barrier
  v_lshl_add_u32 v52, v27, 2, v31
  v_lshrrev_b32 v53, 1, v52
  v_and_b32 v53, 3, v53
  v_xor_b32 v53, s3, v53
  v_lshlrev_b32 v53, 5, v53
  v_lshl_add_u32 v53, v52, 7, v53
  v_lshl_add_u32 v220, v32, 3, v53
  v_and_b32 v52, 1, v1
  v_lshlrev_b32 v52, 10, v52
  v_lshl_add_u32 v52, v27, 3, v52
  v_add_u32 v221, 155904, v52
  ds_read_b64_tr_b16 v[96:97], v220 offset:0
  ds_read_b64_tr_b16 v[98:99], v220 offset:2048
  ds_read_b64_tr_b16 v[100:101], v220 offset:4096
  ds_read_b64_tr_b16 v[102:103], v220 offset:6144
  ds_read_b64_tr_b16 v[104:105], v220 offset:8192
  ds_read_b64_tr_b16 v[106:107], v220 offset:10240
  ds_read_b64_tr_b16 v[108:109], v220 offset:12288
  ds_read_b64_tr_b16 v[110:111], v220 offset:14336
  s_waitcnt lgkmcnt(4)
  ds_read_b64 v[128:129], v221 offset:0
  ds_read_b64 v[130:131], v221 offset:32
  ds_read_b64 v[132:133], v221 offset:64
  ds_read_b64 v[134:135], v221 offset:96
  ds_read_b64 v[136:137], v221 offset:128
  ds_read_b64 v[138:139], v221 offset:160
  ds_read_b64 v[140:141], v221 offset:192
  ds_read_b64 v[142:143], v221 offset:224
  s_waitcnt lgkmcnt(0)
  v_mfma_f32_16x16x32_bf16 v[84:87], v[96:99], v[128:131], 0
  v_mfma_f32_16x16x32_bf16 v[84:87], v[100:103], v[132:135], v[84:87]
  v_mfma_f32_16x16x32_bf16 v[84:87], v[104:107], v[136:139], v[84:87]
  v_mfma_f32_16x16x32_bf16 v[84:87], v[108:111], v[140:143], v[84:87]
  ds_read_b64_tr_b16 v[96:97], v220 offset:16384
  ds_read_b64_tr_b16 v[98:99], v220 offset:18432
  ds_read_b64_tr_b16 v[100:101], v220 offset:20480
  ds_read_b64_tr_b16 v[102:103], v220 offset:22528
  ds_read_b64_tr_b16 v[104:105], v220 offset:24576
  ds_read_b64_tr_b16 v[106:107], v220 offset:26624
  ds_read_b64_tr_b16 v[108:109], v220 offset:28672
  ds_read_b64_tr_b16 v[110:111], v220 offset:30720
  s_waitcnt lgkmcnt(4)
  ds_read_b64 v[128:129], v221 offset:256
  ds_read_b64 v[130:131], v221 offset:288
  ds_read_b64 v[132:133], v221 offset:320
  ds_read_b64 v[134:135], v221 offset:352
  ds_read_b64 v[136:137], v221 offset:384
  ds_read_b64 v[138:139], v221 offset:416
  ds_read_b64 v[140:141], v221 offset:448
  ds_read_b64 v[142:143], v221 offset:480
  s_waitcnt lgkmcnt(0)
  v_mfma_f32_16x16x32_bf16 v[84:87], v[96:99], v[128:131], v[84:87]
  v_mfma_f32_16x16x32_bf16 v[84:87], v[100:103], v[132:135], v[84:87]
  v_mfma_f32_16x16x32_bf16 v[84:87], v[104:107], v[136:139], v[84:87]
  v_mfma_f32_16x16x32_bf16 v[84:87], v[108:111], v[140:143], v[84:87]
  ds_read_b64_tr_b16 v[96:97], v220 offset:32768
  ds_read_b64_tr_b16 v[98:99], v220 offset:34816
  ds_read_b64_tr_b16 v[100:101], v220 offset:36864
  ds_read_b64_tr_b16 v[102:103], v220 offset:38912
  ds_read_b64_tr_b16 v[104:105], v220 offset:40960
  ds_read_b64_tr_b16 v[106:107], v220 offset:43008
  ds_read_b64_tr_b16 v[108:109], v220 offset:45056
  ds_read_b64_tr_b16 v[110:111], v220 offset:47104
  s_waitcnt lgkmcnt(4)
  ds_read_b64 v[128:129], v221 offset:512
  ds_read_b64 v[130:131], v221 offset:544
  ds_read_b64 v[132:133], v221 offset:576
  ds_read_b64 v[134:135], v221 offset:608
  ds_read_b64 v[136:137], v221 offset:640
  ds_read_b64 v[138:139], v221 offset:672
  ds_read_b64 v[140:141], v221 offset:704
  ds_read_b64 v[142:143], v221 offset:736
  s_waitcnt lgkmcnt(0)
  v_mfma_f32_16x16x32_bf16 v[84:87], v[96:99], v[128:131], v[84:87]
  v_mfma_f32_16x16x32_bf16 v[84:87], v[100:103], v[132:135], v[84:87]
  v_mfma_f32_16x16x32_bf16 v[84:87], v[104:107], v[136:139], v[84:87]
  v_mfma_f32_16x16x32_bf16 v[84:87], v[108:111], v[140:143], v[84:87]
  ds_read_b64_tr_b16 v[96:97], v220 offset:49152
  ds_read_b64_tr_b16 v[98:99], v220 offset:51200
  ds_read_b64_tr_b16 v[100:101], v220 offset:53248
  ds_read_b64_tr_b16 v[102:103], v220 offset:55296
  ds_read_b64_tr_b16 v[104:105], v220 offset:57344
  ds_read_b64_tr_b16 v[106:107], v220 offset:59392
  ds_read_b64_tr_b16 v[108:109], v220 offset:61440
  ds_read_b64_tr_b16 v[110:111], v220 offset:63488
  s_waitcnt lgkmcnt(4)
  ds_read_b64 v[128:129], v221 offset:768
  ds_read_b64 v[130:131], v221 offset:800
  ds_read_b64 v[132:133], v221 offset:832
  ds_read_b64 v[134:135], v221 offset:864
  ds_read_b64 v[136:137], v221 offset:896
  ds_read_b64 v[138:139], v221 offset:928
  ds_read_b64 v[140:141], v221 offset:960
  ds_read_b64 v[142:143], v221 offset:992
  s_waitcnt lgkmcnt(0)
  v_mfma_f32_16x16x32_bf16 v[84:87], v[96:99], v[128:131], v[84:87]
  v_mfma_f32_16x16x32_bf16 v[84:87], v[100:103], v[132:135], v[84:87]
  v_mfma_f32_16x16x32_bf16 v[84:87], v[104:107], v[136:139], v[84:87]
  v_mfma_f32_16x16x32_bf16 v[84:87], v[108:111], v[140:143], v[84:87]
  s_waitcnt vmcnt(16)
  v_lshlrev_b32 v52, 16, v236
  v_and_b32 v53, 0xffff0000, v236
  v_lshlrev_b32 v54, 16, v237
  v_and_b32 v55, 0xffff0000, v237
  s_nop 2
  v_cvt_pk_bf16_f32 v56, v84, v84
  v_and_b32 v56, 0xffff0000, v56
  v_add_f32 v56, v56, v52
  v_cvt_pk_bf16_f32 v56, v56, v56
  v_and_b32 v56, 0xffff0000, v56
  v_cvt_pk_bf16_f32 v57, v85, v85
  v_and_b32 v57, 0xffff0000, v57
  v_add_f32 v57, v57, v53
  v_cvt_pk_bf16_f32 v57, v57, v57
  v_and_b32 v57, 0xffff0000, v57
  v_cvt_pk_bf16_f32 v58, v86, v86
  v_and_b32 v58, 0xffff0000, v58
  v_add_f32 v58, v58, v54
  v_cvt_pk_bf16_f32 v58, v58, v58
  v_and_b32 v58, 0xffff0000, v58
  v_cvt_pk_bf16_f32 v59, v87, v87
  v_and_b32 v59, 0xffff0000, v59
  v_add_f32 v59, v59, v55
  v_cvt_pk_bf16_f32 v59, v59, v59
  v_and_b32 v59, 0xffff0000, v59
  v_mul_f32 v84, v56, v56
  v_mul_f32 v84, 0x3d372713, v84
  v_add_f32 v84, 1.0, v84
  v_mul_f32 v84, v84, v56
  v_mul_f32 v84, 0xc0135761, v84
  v_exp_f32 v84, v84
  s_nop 0
  v_add_f32 v84, 1.0, v84
  v_rcp_f32 v84, v84
  s_nop 0
  v_mul_f32 v56, v56, v84
  v_mul_f32 v85, v57, v57
  v_mul_f32 v85, 0x3d372713, v85
  v_add_f32 v85, 1.0, v85
  v_mul_f32 v85, v85, v57
  v_mul_f32 v85, 0xc0135761, v85
  v_exp_f32 v85, v85
  s_nop 0
  v_add_f32 v85, 1.0, v85
  v_rcp_f32 v85, v85
  s_nop 0
  v_mul_f32 v57, v57, v85
  v_mul_f32 v86, v58, v58
  v_mul_f32 v86, 0x3d372713, v86
  v_add_f32 v86, 1.0, v86
  v_mul_f32 v86, v86, v58
  v_mul_f32 v86, 0xc0135761, v86
  v_exp_f32 v86, v86
  s_nop 0
  v_add_f32 v86, 1.0, v86
  v_rcp_f32 v86, v86
  s_nop 0
  v_mul_f32 v58, v58, v86
  v_mul_f32 v87, v59, v59
  v_mul_f32 v87, 0x3d372713, v87
  v_add_f32 v87, 1.0, v87
  v_mul_f32 v87, v87, v59
  v_mul_f32 v87, 0xc0135761, v87
  v_exp_f32 v87, v87
  s_nop 0
  v_add_f32 v87, 1.0, v87
  v_rcp_f32 v87, v87
  s_nop 0
  v_mul_f32 v59, v59, v87
  v_cvt_pk_bf16_f32 v52, v56, v57
  v_cvt_pk_bf16_f32 v53, v58, v59
  v_lshlrev_b32 v54, 7, v28
  v_lshl_add_u32 v54, v27, 3, v54
  s_lshl_b32 s58, s3, 5
  s_add_u32 s58, s58, 158976
  v_add_u32 v54, s58, v54
  v_cmp_gt_u32 vcc, 2, v28
  s_nop 0
  s_and_saveexec_b64 s[62:63], vcc
  ds_write_b64 v54, v[52:53]
  s_mov_b64 exec, s[62:63]
  s_waitcnt vmcnt(0) lgkmcnt(0)
  s_barrier
  v_and_b32 v52, 1, v1
  v_lshlrev_b32 v52, 7, v52
  v_lshl_add_u32 v52, v27, 3, v52
  v_add_u32 v52, 158976, v52
  ds_read_b64 v[68:69], v52 offset:0
  ds_read_b64 v[70:71], v52 offset:32
  ds_read_b64 v[72:73], v52 offset:64
  ds_read_b64 v[74:75], v52 offset:96
  s_lshl_b32 s60, s3, 14
  s_add_u32 s60, s60, 65536
  v_lshlrev_b32 v60, 16, v28
  v_lshl_add_u32 v60, v27, 4, v60
  s_lshl_b32 s58, s3, 14
  s_lshl_b32 s59, s66, 7
  s_add_u32 s58, s58, s59
  s_add_u32 s58, s58, 196608
  v_xor_b32 v53, 0, v33
  v_add_u32 v53, s60, v53
  ds_read_b64_tr_b16 v[96:97], v53 offset:0
  ds_read_b64_tr_b16 v[98:99], v53 offset:4096
  ds_read_b64_tr_b16 v[100:101], v53 offset:8192
  ds_read_b64_tr_b16 v[102:103], v53 offset:12288
  s_waitcnt lgkmcnt(0)
  v_mfma_f32_16x16x32_bf16 v[84:87], v[96:99], v[68:71], 0
  v_mfma_f32_16x16x32_bf16 v[84:87], v[100:103], v[72:75], v[84:87]
  v_cmp_gt_u32 vcc, 2, v28
  s_nop 0
  s_and_saveexec_b64 s[62:63], vcc
  s_nop 4
  v_bfi_b32 v56, v21, v84, v20
  v_bfi_b32 v57, v21, v85, v20
  v_bfi_b32 v58, v21, v86, v20
  v_bfi_b32 v59, v21, v87, v20
  s_add_u32 s59, s58, 0
  buffer_store_dwordx4 v[56:59], v60, s[12:15], s59 offen sc1
  s_mov_b64 exec, s[62:63]
  v_xor_b32 v53, 32, v33
  v_add_u32 v53, s60, v53
  ds_read_b64_tr_b16 v[96:97], v53 offset:0
  ds_read_b64_tr_b16 v[98:99], v53 offset:4096
  ds_read_b64_tr_b16 v[100:101], v53 offset:8192
  ds_read_b64_tr_b16 v[102:103], v53 offset:12288
  s_waitcnt lgkmcnt(0)
  v_mfma_f32_16x16x32_bf16 v[84:87], v[96:99], v[68:71], 0
  v_mfma_f32_16x16x32_bf16 v[84:87], v[100:103], v[72:75], v[84:87]
  v_cmp_gt_u32 vcc, 2, v28
  s_nop 0
  s_and_saveexec_b64 s[62:63], vcc
  s_nop 4
  v_bfi_b32 v56, v21, v84, v20
  v_bfi_b32 v57, v21, v85, v20
  v_bfi_b32 v58, v21, v86, v20
  v_bfi_b32 v59, v21, v87, v20
  s_add_u32 s59, s58, 64
  buffer_store_dwordx4 v[56:59], v60, s[12:15], s59 offen sc1
  s_mov_b64 exec, s[62:63]
  v_xor_b32 v53, 64, v33
  v_add_u32 v53, s60, v53
  ds_read_b64_tr_b16 v[96:97], v53 offset:0
  ds_read_b64_tr_b16 v[98:99], v53 offset:4096
  ds_read_b64_tr_b16 v[100:101], v53 offset:8192
  ds_read_b64_tr_b16 v[102:103], v53 offset:12288
  s_waitcnt lgkmcnt(0)
  v_mfma_f32_16x16x32_bf16 v[84:87], v[96:99], v[68:71], 0
  v_mfma_f32_16x16x32_bf16 v[84:87], v[100:103], v[72:75], v[84:87]
  v_cmp_gt_u32 vcc, 2, v28
  s_nop 0
  s_and_saveexec_b64 s[62:63], vcc
  s_nop 4
  v_bfi_b32 v56, v21, v84, v20
  v_bfi_b32 v57, v21, v85, v20
  v_bfi_b32 v58, v21, v86, v20
  v_bfi_b32 v59, v21, v87, v20
  s_add_u32 s59, s58, 4096
  buffer_store_dwordx4 v[56:59], v60, s[12:15], s59 offen sc1
  s_mov_b64 exec, s[62:63]
  v_xor_b32 v53, 96, v33
  v_add_u32 v53, s60, v53
  ds_read_b64_tr_b16 v[96:97], v53 offset:0
  ds_read_b64_tr_b16 v[98:99], v53 offset:4096
  ds_read_b64_tr_b16 v[100:101], v53 offset:8192
  ds_read_b64_tr_b16 v[102:103], v53 offset:12288
  s_waitcnt lgkmcnt(0)
  v_mfma_f32_16x16x32_bf16 v[84:87], v[96:99], v[68:71], 0
  v_mfma_f32_16x16x32_bf16 v[84:87], v[100:103], v[72:75], v[84:87]
  v_cmp_gt_u32 vcc, 2, v28
  s_nop 0
  s_and_saveexec_b64 s[62:63], vcc
  s_nop 4
  v_bfi_b32 v56, v21, v84, v20
  v_bfi_b32 v57, v21, v85, v20
  v_bfi_b32 v58, v21, v86, v20
  v_bfi_b32 v59, v21, v87, v20
  s_add_u32 s59, s58, 4160
  buffer_store_dwordx4 v[56:59], v60, s[12:15], s59 offen sc1
  s_mov_b64 exec, s[62:63]
  v_xor_b32 v53, 128, v33
  v_add_u32 v53, s60, v53
  ds_read_b64_tr_b16 v[96:97], v53 offset:0
  ds_read_b64_tr_b16 v[98:99], v53 offset:4096
  ds_read_b64_tr_b16 v[100:101], v53 offset:8192
  ds_read_b64_tr_b16 v[102:103], v53 offset:12288
  s_waitcnt lgkmcnt(0)
  v_mfma_f32_16x16x32_bf16 v[84:87], v[96:99], v[68:71], 0
  v_mfma_f32_16x16x32_bf16 v[84:87], v[100:103], v[72:75], v[84:87]
  v_cmp_gt_u32 vcc, 2, v28
  s_nop 0
  s_and_saveexec_b64 s[62:63], vcc
  s_nop 4
  v_bfi_b32 v56, v21, v84, v20
  v_bfi_b32 v57, v21, v85, v20
  v_bfi_b32 v58, v21, v86, v20
  v_bfi_b32 v59, v21, v87, v20
  s_add_u32 s59, s58, 8192
  buffer_store_dwordx4 v[56:59], v60, s[12:15], s59 offen sc1
  s_mov_b64 exec, s[62:63]
  v_xor_b32 v53, 160, v33
  v_add_u32 v53, s60, v53
  ds_read_b64_tr_b16 v[96:97], v53 offset:0
  ds_read_b64_tr_b16 v[98:99], v53 offset:4096
  ds_read_b64_tr_b16 v[100:101], v53 offset:8192
  ds_read_b64_tr_b16 v[102:103], v53 offset:12288
  s_waitcnt lgkmcnt(0)
  v_mfma_f32_16x16x32_bf16 v[84:87], v[96:99], v[68:71], 0
  v_mfma_f32_16x16x32_bf16 v[84:87], v[100:103], v[72:75], v[84:87]
  v_cmp_gt_u32 vcc, 2, v28
  s_nop 0
  s_and_saveexec_b64 s[62:63], vcc
  s_nop 4
  v_bfi_b32 v56, v21, v84, v20
  v_bfi_b32 v57, v21, v85, v20
  v_bfi_b32 v58, v21, v86, v20
  v_bfi_b32 v59, v21, v87, v20
  s_add_u32 s59, s58, 8256
  buffer_store_dwordx4 v[56:59], v60, s[12:15], s59 offen sc1
  s_mov_b64 exec, s[62:63]
  v_xor_b32 v53, 192, v33
  v_add_u32 v53, s60, v53
  ds_read_b64_tr_b16 v[96:97], v53 offset:0
  ds_read_b64_tr_b16 v[98:99], v53 offset:4096
  ds_read_b64_tr_b16 v[100:101], v53 offset:8192
  ds_read_b64_tr_b16 v[102:103], v53 offset:12288
  s_waitcnt lgkmcnt(0)
  v_mfma_f32_16x16x32_bf16 v[84:87], v[96:99], v[68:71], 0
  v_mfma_f32_16x16x32_bf16 v[84:87], v[100:103], v[72:75], v[84:87]
  v_cmp_gt_u32 vcc, 2, v28
  s_nop 0
  s_and_saveexec_b64 s[62:63], vcc
  s_nop 4
  v_bfi_b32 v56, v21, v84, v20
  v_bfi_b32 v57, v21, v85, v20
  v_bfi_b32 v58, v21, v86, v20
  v_bfi_b32 v59, v21, v87, v20
  s_add_u32 s59, s58, 12288
  buffer_store_dwordx4 v[56:59], v60, s[12:15], s59 offen sc1
  s_mov_b64 exec, s[62:63]
  v_xor_b32 v53, 224, v33
  v_add_u32 v53, s60, v53
  ds_read_b64_tr_b16 v[96:97], v53 offset:0
  ds_read_b64_tr_b16 v[98:99], v53 offset:4096
  ds_read_b64_tr_b16 v[100:101], v53 offset:8192
  ds_read_b64_tr_b16 v[102:103], v53 offset:12288
  s_waitcnt lgkmcnt(0)
  v_mfma_f32_16x16x32_bf16 v[84:87], v[96:99], v[68:71], 0
  v_mfma_f32_16x16x32_bf16 v[84:87], v[100:103], v[72:75], v[84:87]
  v_cmp_gt_u32 vcc, 2, v28
  s_nop 0
  s_and_saveexec_b64 s[62:63], vcc
  s_nop 4
  v_bfi_b32 v56, v21, v84, v20
  v_bfi_b32 v57, v21, v85, v20
  v_bfi_b32 v58, v21, v86, v20
  v_bfi_b32 v59, v21, v87, v20
  s_add_u32 s59, s58, 12352
  buffer_store_dwordx4 v[56:59], v60, s[12:15], s59 offen sc1
  s_mov_b64 exec, s[62:63]
  s_barrier
  s_add_u32 s56, s61, s76
  s_and_b32 s56, s56, 1023
  s_lshl_b32 s56, s56, 13
  s_add_u32 m0, s53, 0
  s_add_u32 s56, s56, s54
  buffer_load_dwordx4 v2, s[4:7], s56 offen offset:0 nt lds
  buffer_load_dwordx4 v3, s[4:7], s56 offen offset:1024 nt lds
  buffer_load_dwordx4 v4, s[4:7], s56 offen offset:2048 nt lds
  buffer_load_dwordx4 v5, s[4:7], s56 offen offset:3072 nt lds
  s_add_u32 m0, s53, 4096
  s_add_u32 s56, s56, 4096
  buffer_load_dwordx4 v2, s[4:7], s56 offen offset:0 nt lds
  buffer_load_dwordx4 v3, s[4:7], s56 offen offset:1024 nt lds
  buffer_load_dwordx4 v4, s[4:7], s56 offen offset:2048 nt lds
  buffer_load_dwordx4 v5, s[4:7], s56 offen offset:3072 nt lds
  s_add_u32 s56, s61, s76
  s_and_b32 s56, s56, 1023
  s_lshl_b32 s56, s56, 13
  s_add_u32 m0, s53, 8192
  s_add_u32 s56, s56, s54
  buffer_load_dwordx4 v6, s[8:11], s56 offen offset:0 nt lds
  buffer_load_dwordx4 v7, s[8:11], s56 offen offset:1024 nt lds
  buffer_load_dwordx4 v6, s[8:11], s56 offen offset:2048 nt lds
  buffer_load_dwordx4 v7, s[8:11], s56 offen offset:3072 nt lds
  s_add_u32 m0, s53, 12288
  s_add_u32 s56, s56, 4096
  buffer_load_dwordx4 v6, s[8:11], s56 offen offset:0 nt lds
  buffer_load_dwordx4 v7, s[8:11], s56 offen offset:1024 nt lds
  buffer_load_dwordx4 v6, s[8:11], s56 offen offset:2048 nt lds
  buffer_load_dwordx4 v7, s[8:11], s56 offen offset:3072 nt lds
L_noffn_8:
  s_lshl_b32 s58, s51, 14
  s_lshl_b32 s59, s50, 13
  s_add_u32 s58, s58, s59
  s_lshl_b32 s59, s3, 11
  s_add_u32 s58, s58, s59
  s_add_u32 s60, s58, 65536
  s_add_u32 s55, s61, 64
  s_mov_b32 s65, 400000
  buffer_load_dwordx4 v[224:227], v34, s[12:15], s60 offen sc1
  buffer_load_dwordx4 v[228:231], v34, s[12:15], s60 offen offset:1024 sc1
  s_add_u32 s56, s55, s76
  s_and_b32 s56, s56, 1023
  s_lshl_b32 s56, s56, 13
  s_add_u32 m0, s53, 16384
  s_add_u32 s56, s56, s54
  buffer_load_dwordx4 v2, s[4:7], s56 offen offset:0 nt lds
  buffer_load_dwordx4 v3, s[4:7], s56 offen offset:1024 nt lds
  buffer_load_dwordx4 v4, s[4:7], s56 offen offset:2048 nt lds
  buffer_load_dwordx4 v5, s[4:7], s56 offen offset:3072 nt lds
  s_add_u32 m0, s53, 20480
  s_add_u32 s56, s56, 4096
  buffer_load_dwordx4 v2, s[4:7], s56 offen offset:0 nt lds
  buffer_load_dwordx4 v3, s[4:7], s56 offen offset:1024 nt lds
  buffer_load_dwordx4 v4, s[4:7], s56 offen offset:2048 nt lds
  buffer_load_dwordx4 v5, s[4:7], s56 offen offset:3072 nt lds
  v_mul_u32_u24 v35, 528, v28
  v_lshl_add_u32 v35, v27, 4, v35
  s_mul_i32 s58, s3, 2112
  s_add_u32 s58, s58, 147456
  v_add_u32 v35, s58, v35
  s_lshl_b32 s58, s3, 5
  s_add_u32 s58, s58, 159488
  v_lshlrev_b32 v36, 3, v28
  v_add_u32 v36, s58, v36
  v_and_b32 v37, 31, v1
  v_lshlrev_b32 v37, 4, v37
  s_mul_i32 s58, s3, 528
  s_add_u32 s58, s58, 147456
  v_add_u32 v37, s58, v37
  s_lshl_b32 s58, s3, 3
  s_add_u32 s58, s58, 159488
  v_mov_b32 v38, s58
  s_lshl_b32 s58, s51, 2
  s_add_u32 s58, s58, s3
  s_lshl_b32 s69, s58, 14
  s_lshl_b32 s59, s52, 7
  s_add_u32 s69, s69, s59
  s_add_u32 s69, s69, 393216
  v_and_b32 v39, 3, v29
  v_lshlrev_b32 v39, 12, v39
  v_lshl_add_u32 v39, v30, 4, v39
  s_lshl_b32 s70, s58, 12
  s_lshl_b32 s59, s52, 7
  s_add_u32 s70, s70, s59
  s_add_u32 s70, s70, 1310720
  s_lshr_b32 s58, s52, 2
  s_lshl_b32 s59, s51, 3
  s_add_u32 s59, s59, s58
  s_lshl_b32 s73, s59, 7
  s_lshl_b32 s71, s59, 1
  s_lshr_b32 s58, s3, 1
  s_add_u32 s71, s71, s58
  s_lshl_b32 s71, s71, 1
  s_and_b32 s58, s3, 1
  s_add_u32 s71, s71, s58
  s_lshl_b32 s71, s71, 11
  s_add_u32 s71, s71, 393216
  s_lshr_b32 s72, s59, 1
  s_lshl_b32 s72, s72, 1
  s_add_u32 s72, s72, s58
  s_lshl_b32 s72, s72, 11
  s_add_u32 s72, s72, 1310720
  v_lshlrev_b32 v40, 7, v29
  v_lshrrev_b32 v60, 5, v1
  v_lshlrev_b32 v60, 1, v60
  v_and_b32 v61, 1, v27
  v_add_u32 v60, v60, v61
  v_lshl_add_u32 v44, v30, 2, v60
  s_and_b32 s58, s3, 1
  s_lshl_b32 s58, s58, 7
  s_lshr_b32 s59, s3, 1
  s_lshl_b32 s59, s59, 6
  s_add_u32 s58, s58, s59
  s_add_u32 s58, s58, 159232
  v_lshlrev_b32 v41, 1, v44
  v_add_u32 v41, s58, v41
  v_and_b32 v60, 1, v1
  v_lshlrev_b32 v42, 7, v60
  v_lshl_add_u32 v42, v27, 3, v42
  v_add_u32 v42, 159232, v42
  s_lshl_b32 s58, s3, 6
  v_xor_b32 v45, s58, v33
  v_xor_b32 v46, 32, v45
  v_add_u32 v45, 131072, v45
  v_add_u32 v46, 131072, v46
  s_and_b32 s58, s52, 3
  s_lshl_b32 s58, s58, 2
  s_add_u32 s58, s58, s3
  s_lshl_b32 s58, s58, 13
  s_add_u32 s73, s73, s58
  s_add_u32 s73, s73, 1048576
  v_lshlrev_b32 v43, 17, v60
  v_lshl_add_u32 v43, v27, 4, v43
  v_and_b32 v61, 2, v1
  v_lshl_add_u32 v43, v61, 5, v43
  s_lshr_b32 s58, s2, 3
  s_xor_b32 s59, s58, s2
  s_and_b32 s59, s59, 7
  s_cmp_eq_u32 s59, 0
  s_cselect_b32 s74, s58, 255
  s_waitcnt vmcnt(8)
  v_xor_b32 v52, v224, v20
  v_xor_b32 v53, v225, v20
  v_xor_b32 v54, v226, v20
  v_or3_b32 v52, v52, v53, v54
  v_xor_b32 v53, v227, v20
  v_xor_b32 v54, v228, v20
  v_or3_b32 v52, v52, v53, v54
  v_xor_b32 v53, v229, v20
  v_xor_b32 v54, v230, v20
  v_or3_b32 v52, v52, v53, v54
  v_xor_b32 v53, v231, v20
  v_or_b32 v52, v52, v53
  v_and_b32 v52, 1023, v52
  v_cmp_ne_u32 vcc, 0, v52
  s_nop 0
  s_cbranch_vccnz L_qf1_9
  s_add_u32 s56, s55, s76
  s_and_b32 s56, s56, 1023
  s_lshl_b32 s56, s56, 13
  s_add_u32 m0, s53, 24576
  s_add_u32 s56, s56, s54
  buffer_load_dwordx4 v6, s[8:11], s56 offen offset:0 nt lds
  buffer_load_dwordx4 v7, s[8:11], s56 offen offset:1024 nt lds
  buffer_load_dwordx4 v6, s[8:11], s56 offen offset:2048 nt lds
  buffer_load_dwordx4 v7, s[8:11], s56 offen offset:3072 nt lds
  s_add_u32 m0, s53, 28672
  s_add_u32 s56, s56, 4096
  buffer_load_dwordx4 v6, s[8:11], s56 offen offset:0 nt lds
  buffer_load_dwordx4 v7, s[8:11], s56 offen offset:1024 nt lds
  buffer_load_dwordx4 v6, s[8:11], s56 offen offset:2048 nt lds
  buffer_load_dwordx4 v7, s[8:11], s56 offen offset:3072 nt lds
  s_branch L_qok_11
L_qf1_9:
  buffer_load_dwordx4 v[224:227], v34, s[12:15], s60 offen sc1
  buffer_load_dwordx4 v[228:231], v34, s[12:15], s60 offen offset:1024 sc1
  s_add_u32 s56, s55, s76
  s_and_b32 s56, s56, 1023
  s_lshl_b32 s56, s56, 13
  s_add_u32 m0, s53, 24576
  s_add_u32 s56, s56, s54
  buffer_load_dwordx4 v6, s[8:11], s56 offen offset:0 nt lds
  buffer_load_dwordx4 v7, s[8:11], s56 offen offset:1024 nt lds
  buffer_load_dwordx4 v6, s[8:11], s56 offen offset:2048 nt lds
  buffer_load_dwordx4 v7, s[8:11], s56 offen offset:3072 nt lds
  s_add_u32 m0, s53, 28672
  s_add_u32 s56, s56, 4096
  buffer_load_dwordx4 v6, s[8:11], s56 offen offset:0 nt lds
  buffer_load_dwordx4 v7, s[8:11], s56 offen offset:1024 nt lds
  buffer_load_dwordx4 v6, s[8:11], s56 offen offset:2048 nt lds
  buffer_load_dwordx4 v7, s[8:11], s56 offen offset:3072 nt lds
  s_waitcnt vmcnt(8)
  v_xor_b32 v52, v224, v20
  v_xor_b32 v53, v225, v20
  v_xor_b32 v54, v226, v20
  v_or3_b32 v52, v52, v53, v54
  v_xor_b32 v53, v227, v20
  v_xor_b32 v54, v228, v20
  v_or3_b32 v52, v52, v53, v54
  v_xor_b32 v53, v229, v20
  v_xor_b32 v54, v230, v20
  v_or3_b32 v52, v52, v53, v54
  v_xor_b32 v53, v231, v20
  v_or_b32 v52, v52, v53
  v_and_b32 v52, 1023, v52
  v_cmp_ne_u32 vcc, 0, v52
  s_nop 0
  s_cbranch_vccnz L_qf2_10
  s_branch L_qok_11
L_qf2_10:
L_qretry_12:
  buffer_load_dwordx4 v[224:227], v34, s[12:15], s60 offen sc1
  buffer_load_dwordx4 v[228:231], v34, s[12:15], s60 offen offset:1024 sc1
  s_waitcnt vmcnt(0)
  v_xor_b32 v52, v224, v20
  v_xor_b32 v53, v225, v20
  v_xor_b32 v54, v226, v20
  v_or3_b32 v52, v52, v53, v54
  v_xor_b32 v53, v227, v20
  v_xor_b32 v54, v228, v20
  v_or3_b32 v52, v52, v53, v54
  v_xor_b32 v53, v229, v20
  v_xor_b32 v54, v230, v20
  v_or3_b32 v52, v52, v53, v54
  v_xor_b32 v53, v231, v20
  v_or_b32 v52, v52, v53
  v_and_b32 v52, 1023, v52
  v_cmp_ne_u32 vcc, 0, v52
  s_nop 0
  s_cbranch_vccnz L_qfail_13
  s_branch L_qok_11
L_qfail_13:
  s_sub_u32 s65, s65, 1
  s_cmp_lg_u32 s65, 0
  s_cbranch_scc1 L_qretry_12
  s_or_b32 s67, s67, 1
L_qok_11:
  v_and_b32 v224, v21, v224
  v_and_b32 v225, v21, v225
  v_and_b32 v226, v21, v226
  v_and_b32 v227, v21, v227
  v_and_b32 v228, v21, v228
  v_and_b32 v229, v21, v229
  v_and_b32 v230, v21, v230
  v_and_b32 v231, v21, v231
  v_permlane32_swap_b32 v224, v228
  v_permlane32_swap_b32 v225, v229
  v_permlane32_swap_b32 v226, v230
  v_permlane32_swap_b32 v227, v231
  v_add_f32 v224, v224, v228
  v_add_f32 v225, v225, v229
  v_add_f32 v226, v226, v230
  v_add_f32 v227, v227, v231
  s_nop 0
  v_permlane16_swap_b32 v224, v226
  v_permlane16_swap_b32 v225, v227
  v_lshrrev_b32 v52, 5, v1
  v_lshlrev_b32 v52, 7, v52
  v_add_f32 v224, v224, v226
  v_add_f32 v225, v225, v227
  v_lshl_add_u32 v52, v28, 3, v52
  v_and_b32 v53, 1, v27
  v_lshl_add_u32 v52, v53, 2, v52
  s_lshl_b32 s58, s3, 8
  s_add_u32 s58, s58, 157952
  v_cvt_pk_bf16_f32 v224, v224, v225
  v_add_u32 v52, s58, v52
  ds_write_b32 v52, v224
  v_and_b32 v56, 3, v1
  v_lshlrev_b32 v56, 8, v56
  v_lshl_add_u32 v56, v27, 4, v56
  v_add_u32 v56, 157952, v56
  v_mov_b32 v24, 0xff800000
  v_mov_b32 v26, 0xff800000
  v_mov_b32 v25, 0
  v_mov_b32 v160, 0
  v_mov_b32 v161, 0
  v_mov_b32 v162, 0
  v_mov_b32 v163, 0
  v_mov_b32 v164, 0
  v_mov_b32 v165, 0
  v_mov_b32 v166, 0
  v_mov_b32 v167, 0
  v_mov_b32 v168, 0
  v_mov_b32 v169, 0
  v_mov_b32 v170, 0
  v_mov_b32 v171, 0
  v_mov_b32 v172, 0
  v_mov_b32 v173, 0
  v_mov_b32 v174, 0
  v_mov_b32 v175, 0
  v_mov_b32 v176, 0
  v_mov_b32 v177, 0
  v_mov_b32 v178, 0
  v_mov_b32 v179, 0
  v_mov_b32 v180, 0
  v_mov_b32 v181, 0
  v_mov_b32 v182, 0
  v_mov_b32 v183, 0
  v_mov_b32 v184, 0
  v_mov_b32 v185, 0
  v_mov_b32 v186, 0
  v_mov_b32 v187, 0
  v_mov_b32 v188, 0
  v_mov_b32 v189, 0
  v_mov_b32 v190, 0
  v_mov_b32 v191, 0
  s_waitcnt lgkmcnt(0)
  s_barrier
  ds_read_b128 v[68:71], v56 offset:0
  ds_read_b128 v[72:75], v56 offset:64
  ds_read_b128 v[76:79], v56 offset:128
  ds_read_b128 v[80:83], v56 offset:192
  s_add_u32 s68, s61, 128
  s_waitcnt lgkmcnt(0)
  ds_read_b128 v[96:99], v8 offset:0
  ds_read_b128 v[112:115], v8 offset:4096
  ds_read_b128 v[100:103], v9 offset:0
  ds_read_b128 v[116:119], v9 offset:4096
  ds_read_b128 v[104:107], v10 offset:0
  ds_read_b128 v[120:123], v10 offset:4096
  ds_read_b128 v[108:111], v11 offset:0
  ds_read_b128 v[124:127], v11 offset:4096
  s_waitcnt lgkmcnt(6)
  v_mfma_f32_16x16x32_bf16 v[84:87], v[96:99], v[68:71], 0
  v_mfma_f32_16x16x32_bf16 v[88:91], v[112:115], v[68:71], 0
  s_waitcnt lgkmcnt(4)
  v_mfma_f32_16x16x32_bf16 v[84:87], v[100:103], v[72:75], v[84:87]
  v_mfma_f32_16x16x32_bf16 v[88:91], v[116:119], v[72:75], v[88:91]
  s_waitcnt lgkmcnt(2)
  v_mfma_f32_16x16x32_bf16 v[84:87], v[104:107], v[76:79], v[84:87]
  v_mfma_f32_16x16x32_bf16 v[88:91], v[120:123], v[76:79], v[88:91]
  s_waitcnt lgkmcnt(0)
  v_mfma_f32_16x16x32_bf16 v[84:87], v[108:111], v[80:83], v[84:87]
  v_mfma_f32_16x16x32_bf16 v[88:91], v[124:127], v[80:83], v[88:91]
  s_add_u32 s56, s68, s76
  s_and_b32 s56, s56, 1023
  s_lshl_b32 s56, s56, 13
  s_add_u32 m0, s53, 0
  s_add_u32 s56, s56, s54
  buffer_load_dwordx4 v2, s[4:7], s56 offen offset:0 nt lds
  buffer_load_dwordx4 v3, s[4:7], s56 offen offset:1024 nt lds
  buffer_load_dwordx4 v4, s[4:7], s56 offen offset:2048 nt lds
  buffer_load_dwordx4 v5, s[4:7], s56 offen offset:3072 nt lds
  s_add_u32 m0, s53, 4096
  s_add_u32 s56, s56, 4096
  buffer_load_dwordx4 v2, s[4:7], s56 offen offset:0 nt lds
  buffer_load_dwordx4 v3, s[4:7], s56 offen offset:1024 nt lds
  buffer_load_dwordx4 v4, s[4:7], s56 offen offset:2048 nt lds
  buffer_load_dwordx4 v5, s[4:7], s56 offen offset:3072 nt lds
  s_mov_b32 s20, s32
  s_and_b32 s21, s33, 0xffff
  s_mov_b32 s22, 4194304
  s_mov_b32 s23, 0x20000
  v_lshlrev_b32 v61, 1, v27
  v_xor_b32 v61, v28, v61
  v_lshlrev_b32 v61, 4, v61
  v_lshl_add_u32 v61, v27, 10, v61
  v_xor_b32 v62, 128, v61
  s_lshr_b32 s58, s52, 2
  s_lshl_b32 s58, s58, 6
  s_lshl_b32 s59, s51, 9
  s_add_u32 s58, s58, s59
  s_lshl_b32 s59, s3, 4
  s_add_u32 s58, s58, s59
  s_lshl_b32 s58, s58, 10
  s_and_b32 s59, s52, 3
  s_lshl_b32 s59, s59, 8
  s_add_u32 s58, s58, s59
  s_lshl_b32 s59, s3, 12
  s_add_u32 m0, s59, 131072
  s_nop 0
  buffer_load_dwordx4 v61, s[20:23], s58 offen offset:0 nt lds
  s_add_u32 s58, s58, 3072
  buffer_load_dwordx4 v62, s[20:23], s58 offen offset:1024 nt lds
  s_add_u32 s58, s58, 3072
  buffer_load_dwordx4 v61, s[20:23], s58 offen offset:2048 nt lds
  s_add_u32 s58, s58, 3072
  buffer_load_dwordx4 v62, s[20:23], s58 offen offset:3072 nt lds
  v_cvt_pk_bf16_f32 v56, v84, v85
  v_cvt_pk_bf16_f32 v57, v86, v87
  v_cvt_pk_bf16_f32 v58, v88, v89
  v_cvt_pk_bf16_f32 v59, v90, v91
  v_lshlrev_b32 v84, 16, v56
  v_and_b32 v85, 0xffff0000, v56
  v_lshlrev_b32 v86, 16, v57
  v_and_b32 v87, 0xffff0000, v57
  v_lshlrev_b32 v88, 16, v58
  v_and_b32 v89, 0xffff0000, v58
  v_lshlrev_b32 v90, 16, v59
  v_and_b32 v91, 0xffff0000, v59
  v_mul_f32 v84, s77, v84
  v_mul_f32 v85, s77, v85
  v_mul_f32 v86, s77, v86
  v_mul_f32 v87, s77, v87
  v_mul_f32 v88, s77, v88
  v_mul_f32 v89, s77, v89
  v_mul_f32 v90, s77, v90
  v_mul_f32 v91, s77, v91
  v_cvt_pk_bf16_f32 v56, v84, v85
  v_cvt_pk_bf16_f32 v57, v86, v87
  v_cvt_pk_bf16_f32 v58, v88, v89
  v_cvt_pk_bf16_f32 v59, v90, v91
  v_lshlrev_b32 v84, 16, v56
  v_and_b32 v85, 0xffff0000, v56
  v_lshlrev_b32 v86, 16, v57
  v_and_b32 v87, 0xffff0000, v57
  v_lshlrev_b32 v88, 16, v58
  v_and_b32 v89, 0xffff0000, v58
  v_lshlrev_b32 v90, 16, v59
  v_and_b32 v91, 0xffff0000, v59
  v_max3_f32 v52, v84, v85, v86
  v_max3_f32 v53, v87, v88, v89
  v_max3_f32 v52, v52, v90, v91
  v_max_f32 v52, v52, v53
  v_mov_b32 v53, v52
  s_nop 1
  v_permlane32_swap_b32 v52, v53
  v_max_f32 v52, v52, v53
  v_mov_b32 v53, v52
  s_nop 1
  v_permlane16_swap_b32 v52, v53
  v_max_f32 v52, v52, v53
  v_cmp_gt_f32 vcc, v52, v24
  s_nop 0
  s_cbranch_vccz L_norescale_14
  v_max_f32 v52, v52, v24
  v_sub_f32 v53, v24, v52
  v_mul_f32 v53, s64, v53
  v_exp_f32 v53, v53
  v_mov_b32 v24, v52
  v_mul_f32 v26, s64, v52
  v_mul_f32 v25, v25, v53
  v_mul_f32 v160, v160, v53
  v_mul_f32 v161, v161, v53
  v_mul_f32 v162, v162, v53
  v_mul_f32 v163, v163, v53
  v_mul_f32 v164, v164, v53
  v_mul_f32 v165, v165, v53
  v_mul_f32 v166, v166, v53
  v_mul_f32 v167, v167, v53
  v_mul_f32 v168, v168, v53
  v_mul_f32 v169, v169, v53
  v_mul_f32 v170, v170, v53
  v_mul_f32 v171, v171, v53
  v_mul_f32 v172, v172, v53
  v_mul_f32 v173, v173, v53
  v_mul_f32 v174, v174, v53
  v_mul_f32 v175, v175, v53
  v_mul_f32 v176, v176, v53
  v_mul_f32 v177, v177, v53
  v_mul_f32 v178, v178, v53
  v_mul_f32 v179, v179, v53
  v_mul_f32 v180, v180, v53
  v_mul_f32 v181, v181, v53
  v_mul_f32 v182, v182, v53
  v_mul_f32 v183, v183, v53
  v_mul_f32 v184, v184, v53
  v_mul_f32 v185, v185, v53
  v_mul_f32 v186, v186, v53
  v_mul_f32 v187, v187, v53
  v_mul_f32 v188, v188, v53
  v_mul_f32 v189, v189, v53
  v_mul_f32 v190, v190, v53
  v_mul_f32 v191, v191, v53
L_norescale_14:
  v_fma_f32 v84, v84, s64, -v26
  v_fma_f32 v85, v85, s64, -v26
  v_fma_f32 v86, v86, s64, -v26
  v_fma_f32 v87, v87, s64, -v26
  v_fma_f32 v88, v88, s64, -v26
  v_fma_f32 v89, v89, s64, -v26
  v_fma_f32 v90, v90, s64, -v26
  v_fma_f32 v91, v91, s64, -v26
  v_exp_f32 v84, v84
  v_exp_f32 v85, v85
  v_exp_f32 v86, v86
  v_exp_f32 v87, v87
  v_exp_f32 v88, v88
  v_exp_f32 v89, v89
  v_exp_f32 v90, v90
  v_exp_f32 v91, v91
  v_add_f32 v52, v84, v85
  v_add_f32 v53, v86, v87
  v_cvt_pk_bf16_f32 v92, v84, v85
  v_cvt_pk_bf16_f32 v93, v86, v87
  v_cvt_pk_bf16_f32 v94, v88, v89
  v_cvt_pk_bf16_f32 v95, v90, v91
  v_add_f32 v52, v52, v88
  v_add_f32 v53, v53, v89
  v_add_f32 v52, v52, v90
  v_add_f32 v53, v53, v91
  v_add_f32 v52, v52, v53
  v_add_f32 v25, v25, v52
  ds_read_b64_tr_b16 v[128:129], v12 offset:8192
  ds_read_b64_tr_b16 v[130:131], v12 offset:12288
  ds_read_b64_tr_b16 v[132:133], v13 offset:8192
  ds_read_b64_tr_b16 v[134:135], v13 offset:12288
  ds_read_b64_tr_b16 v[136:137], v14 offset:8192
  ds_read_b64_tr_b16 v[138:139], v14 offset:12288
  ds_read_b64_tr_b16 v[140:141], v15 offset:8192
  ds_read_b64_tr_b16 v[142:143], v15 offset:12288
  ds_read_b64_tr_b16 v[144:145], v16 offset:8192
  ds_read_b64_tr_b16 v[146:147], v16 offset:12288
  ds_read_b64_tr_b16 v[148:149], v17 offset:8192
  ds_read_b64_tr_b16 v[150:151], v17 offset:12288
  ds_read_b64_tr_b16 v[152:153], v18 offset:8192
  ds_read_b64_tr_b16 v[154:155], v18 offset:12288
  s_waitcnt lgkmcnt(12)
  v_mfma_f32_16x16x32_bf16 v[160:163], v[128:131], v[92:95], v[160:163]
  ds_read_b64_tr_b16 v[156:157], v19 offset:8192
  ds_read_b64_tr_b16 v[158:159], v19 offset:12288
  s_waitcnt lgkmcnt(12)
  v_mfma_f32_16x16x32_bf16 v[164:167], v[132:135], v[92:95], v[164:167]
  s_waitcnt lgkmcnt(10)
  v_mfma_f32_16x16x32_bf16 v[168:171], v[136:139], v[92:95], v[168:171]
  s_waitcnt lgkmcnt(8)
  v_mfma_f32_16x16x32_bf16 v[172:175], v[140:143], v[92:95], v[172:175]
  s_waitcnt lgkmcnt(6)
  v_mfma_f32_16x16x32_bf16 v[176:179], v[144:147], v[92:95], v[176:179]
  s_waitcnt lgkmcnt(4)
  v_mfma_f32_16x16x32_bf16 v[180:183], v[148:151], v[92:95], v[180:183]
  s_waitcnt lgkmcnt(2)
  v_mfma_f32_16x16x32_bf16 v[184:187], v[152:155], v[92:95], v[184:187]
  s_waitcnt lgkmcnt(0)
  v_mfma_f32_16x16x32_bf16 v[188:191], v[156:159], v[92:95], v[188:191]
  s_add_u32 s56, s68, s76
  s_and_b32 s56, s56, 1023
  s_lshl_b32 s56, s56, 13
  s_add_u32 m0, s53, 8192
  s_add_u32 s56, s56, s54
  buffer_load_dwordx4 v6, s[8:11], s56 offen offset:0 nt lds
  buffer_load_dwordx4 v7, s[8:11], s56 offen offset:1024 nt lds
  buffer_load_dwordx4 v6, s[8:11], s56 offen offset:2048 nt lds
  buffer_load_dwordx4 v7, s[8:11], s56 offen offset:3072 nt lds
  s_add_u32 m0, s53, 12288
  s_add_u32 s56, s56, 4096
  buffer_load_dwordx4 v6, s[8:11], s56 offen offset:0 nt lds
  buffer_load_dwordx4 v7, s[8:11], s56 offen offset:1024 nt lds
  buffer_load_dwordx4 v6, s[8:11], s56 offen offset:2048 nt lds
  buffer_load_dwordx4 v7, s[8:11], s56 offen offset:3072 nt lds
  s_waitcnt vmcnt(28)
  ds_read_b128 v[96:99], v8 offset:16384
  ds_read_b128 v[112:115], v8 offset:20480
  ds_read_b128 v[100:103], v9 offset:16384
  ds_read_b128 v[116:119], v9 offset:20480
  ds_read_b128 v[104:107], v10 offset:16384
  ds_read_b128 v[120:123], v10 offset:20480
  ds_read_b128 v[108:111], v11 offset:16384
  ds_read_b128 v[124:127], v11 offset:20480
  s_waitcnt lgkmcnt(6)
  v_mfma_f32_16x16x32_bf16 v[84:87], v[96:99], v[68:71], 0
  v_mfma_f32_16x16x32_bf16 v[88:91], v[112:115], v[68:71], 0
  s_waitcnt lgkmcnt(4)
  v_mfma_f32_16x16x32_bf16 v[84:87], v[100:103], v[72:75], v[84:87]
  v_mfma_f32_16x16x32_bf16 v[88:91], v[116:119], v[72:75], v[88:91]
  s_waitcnt lgkmcnt(2)
  v_mfma_f32_16x16x32_bf16 v[84:87], v[104:107], v[76:79], v[84:87]
  v_mfma_f32_16x16x32_bf16 v[88:91], v[120:123], v[76:79], v[88:91]
  s_waitcnt lgkmcnt(0)
  v_mfma_f32_16x16x32_bf16 v[84:87], v[108:111], v[80:83], v[84:87]
  v_mfma_f32_16x16x32_bf16 v[88:91], v[124:127], v[80:83], v[88:91]
  s_nop 6
  v_cvt_pk_bf16_f32 v56, v84, v85
  v_cvt_pk_bf16_f32 v57, v86, v87
  v_cvt_pk_bf16_f32 v58, v88, v89
  v_cvt_pk_bf16_f32 v59, v90, v91
  v_lshlrev_b32 v84, 16, v56
  v_and_b32 v85, 0xffff0000, v56
  v_lshlrev_b32 v86, 16, v57
  v_and_b32 v87, 0xffff0000, v57
  v_lshlrev_b32 v88, 16, v58
  v_and_b32 v89, 0xffff0000, v58
  v_lshlrev_b32 v90, 16, v59
  v_and_b32 v91, 0xffff0000, v59
  v_mul_f32 v84, s77, v84
  v_mul_f32 v85, s77, v85
  v_mul_f32 v86, s77, v86
  v_mul_f32 v87, s77, v87
  v_mul_f32 v88, s77, v88
  v_mul_f32 v89, s77, v89
  v_mul_f32 v90, s77, v90
  v_mul_f32 v91, s77, v91
  v_cvt_pk_bf16_f32 v56, v84, v85
  v_cvt_pk_bf16_f32 v57, v86, v87
  v_cvt_pk_bf16_f32 v58, v88, v89
  v_cvt_pk_bf16_f32 v59, v90, v91
  v_lshlrev_b32 v84, 16, v56
  v_and_b32 v85, 0xffff0000, v56
  v_lshlrev_b32 v86, 16, v57
  v_and_b32 v87, 0xffff0000, v57
  v_lshlrev_b32 v88, 16, v58
  v_and_b32 v89, 0xffff0000, v58
  v_lshlrev_b32 v90, 16, v59
  v_and_b32 v91, 0xffff0000, v59
  v_max3_f32 v52, v84, v85, v86
  v_max3_f32 v53, v87, v88, v89
  v_max3_f32 v52, v52, v90, v91
  v_max_f32 v52, v52, v53
  v_mov_b32 v53, v52
  s_nop 1
  v_permlane32_swap_b32 v52, v53
  v_max_f32 v52, v52, v53
  v_mov_b32 v53, v52
  s_nop 1
  v_permlane16_swap_b32 v52, v53
  v_max_f32 v52, v52, v53
  v_cmp_gt_f32 vcc, v52, v24
  s_nop 0
  s_cbranch_vccz L_norescale_15
  v_max_f32 v52, v52, v24
  v_sub_f32 v53, v24, v52
  v_mul_f32 v53, s64, v53
  v_exp_f32 v53, v53
  v_mov_b32 v24, v52
  v_mul_f32 v26, s64, v52
  v_mul_f32 v25, v25, v53
  v_mul_f32 v160, v160, v53
  v_mul_f32 v161, v161, v53
  v_mul_f32 v162, v162, v53
  v_mul_f32 v163, v163, v53
  v_mul_f32 v164, v164, v53
  v_mul_f32 v165, v165, v53
  v_mul_f32 v166, v166, v53
  v_mul_f32 v167, v167, v53
  v_mul_f32 v168, v168, v53
  v_mul_f32 v169, v169, v53
  v_mul_f32 v170, v170, v53
  v_mul_f32 v171, v171, v53
  v_mul_f32 v172, v172, v53
  v_mul_f32 v173, v173, v53
  v_mul_f32 v174, v174, v53
  v_mul_f32 v175, v175, v53
  v_mul_f32 v176, v176, v53
  v_mul_f32 v177, v177, v53
  v_mul_f32 v178, v178, v53
  v_mul_f32 v179, v179, v53
  v_mul_f32 v180, v180, v53
  v_mul_f32 v181, v181, v53
  v_mul_f32 v182, v182, v53
  v_mul_f32 v183, v183, v53
  v_mul_f32 v184, v184, v53
  v_mul_f32 v185, v185, v53
  v_mul_f32 v186, v186, v53
  v_mul_f32 v187, v187, v53
  v_mul_f32 v188, v188, v53
  v_mul_f32 v189, v189, v53
  v_mul_f32 v190, v190, v53
  v_mul_f32 v191, v191, v53
L_norescale_15:
  v_fma_f32 v84, v84, s64, -v26
  v_fma_f32 v85, v85, s64, -v26
  v_fma_f32 v86, v86, s64, -v26
  v_fma_f32 v87, v87, s64, -v26
  v_fma_f32 v88, v88, s64, -v26
  v_fma_f32 v89, v89, s64, -v26
  v_fma_f32 v90, v90, s64, -v26
  v_fma_f32 v91, v91, s64, -v26
  v_exp_f32 v84, v84
  v_exp_f32 v85, v85
  v_exp_f32 v86, v86
  v_exp_f32 v87, v87
  v_exp_f32 v88, v88
  v_exp_f32 v89, v89
  v_exp_f32 v90, v90
  v_exp_f32 v91, v91
  v_add_f32 v52, v84, v85
  v_add_f32 v53, v86, v87
  v_cvt_pk_bf16_f32 v92, v84, v85
  v_cvt_pk_bf16_f32 v93, v86, v87
  v_cvt_pk_bf16_f32 v94, v88, v89
  v_cvt_pk_bf16_f32 v95, v90, v91
  v_add_f32 v52, v52, v88
  v_add_f32 v53, v53, v89
  v_add_f32 v52, v52, v90
  v_add_f32 v53, v53, v91
  v_add_f32 v52, v52, v53
  v_add_f32 v25, v25, v52
  s_waitcnt vmcnt(20)
  ds_read_b64_tr_b16 v[128:129], v12 offset:24576
  ds_read_b64_tr_b16 v[130:131], v12 offset:28672
  ds_read_b64_tr_b16 v[132:133], v13 offset:24576
  ds_read_b64_tr_b16 v[134:135], v13 offset:28672
  ds_read_b64_tr_b16 v[136:137], v14 offset:24576
  ds_read_b64_tr_b16 v[138:139], v14 offset:28672
  ds_read_b64_tr_b16 v[140:141], v15 offset:24576
  ds_read_b64_tr_b16 v[142:143], v15 offset:28672
  ds_read_b64_tr_b16 v[144:145], v16 offset:24576
  ds_read_b64_tr_b16 v[146:147], v16 offset:28672
  ds_read_b64_tr_b16 v[148:149], v17 offset:24576
  ds_read_b64_tr_b16 v[150:151], v17 offset:28672
  ds_read_b64_tr_b16 v[152:153], v18 offset:24576
  ds_read_b64_tr_b16 v[154:155], v18 offset:28672
  s_waitcnt lgkmcnt(12)
  v_mfma_f32_16x16x32_bf16 v[160:163], v[128:131], v[92:95], v[160:163]
  ds_read_b64_tr_b16 v[156:157], v19 offset:24576
  ds_read_b64_tr_b16 v[158:159], v19 offset:28672
  s_waitcnt lgkmcnt(12)
  v_mfma_f32_16x16x32_bf16 v[164:167], v[132:135], v[92:95], v[164:167]
  s_waitcnt lgkmcnt(10)
  v_mfma_f32_16x16x32_bf16 v[168:171], v[136:139], v[92:95], v[168:171]
  s_waitcnt lgkmcnt(8)
  v_mfma_f32_16x16x32_bf16 v[172:175], v[140:143], v[92:95], v[172:175]
  s_waitcnt lgkmcnt(6)
  v_mfma_f32_16x16x32_bf16 v[176:179], v[144:147], v[92:95], v[176:179]
  s_waitcnt lgkmcnt(4)
  v_mfma_f32_16x16x32_bf16 v[180:183], v[148:151], v[92:95], v[180:183]
  s_waitcnt lgkmcnt(2)
  v_mfma_f32_16x16x32_bf16 v[184:187], v[152:155], v[92:95], v[184:187]
  s_waitcnt lgkmcnt(0)
  v_mfma_f32_16x16x32_bf16 v[188:191], v[156:159], v[92:95], v[188:191]
L_loop:
L_body0:
  s_waitcnt vmcnt(8)
  s_mov_b64 exec, 1
  v_mov_b32 v22, 1
  buffer_atomic_add v22, v23, s[12:15], s57 offen sc0
  s_mov_b64 exec, -1
  ds_read_b128 v[96:99], v8 offset:0
  ds_read_b128 v[112:115], v8 offset:4096
  ds_read_b128 v[100:103], v9 offset:0
  ds_read_b128 v[116:119], v9 offset:4096
  ds_read_b128 v[104:107], v10 offset:0
  ds_read_b128 v[120:123], v10 offset:4096
  ds_read_b128 v[108:111], v11 offset:0
  ds_read_b128 v[124:127], v11 offset:4096
  s_waitcnt lgkmcnt(6)
  v_mfma_f32_16x16x32_bf16 v[84:87], v[96:99], v[68:71], 0
  v_mfma_f32_16x16x32_bf16 v[88:91], v[112:115], v[68:71], 0
  s_waitcnt lgkmcnt(4)
  v_mfma_f32_16x16x32_bf16 v[84:87], v[100:103], v[72:75], v[84:87]
  v_mfma_f32_16x16x32_bf16 v[88:91], v[116:119], v[72:75], v[88:91]
  s_waitcnt lgkmcnt(2)
  v_mfma_f32_16x16x32_bf16 v[84:87], v[104:107], v[76:79], v[84:87]
  v_mfma_f32_16x16x32_bf16 v[88:91], v[120:123], v[76:79], v[88:91]
  s_waitcnt lgkmcnt(0)
  v_mfma_f32_16x16x32_bf16 v[84:87], v[108:111], v[80:83], v[84:87]
  v_mfma_f32_16x16x32_bf16 v[88:91], v[124:127], v[80:83], v[88:91]
  s_nop 6
  v_cvt_pk_bf16_f32 v56, v84, v85
  v_cvt_pk_bf16_f32 v57, v86, v87
  v_cvt_pk_bf16_f32 v58, v88, v89
  v_cvt_pk_bf16_f32 v59, v90, v91
  v_lshlrev_b32 v84, 16, v56
  v_and_b32 v85, 0xffff0000, v56
  v_lshlrev_b32 v86, 16, v57
  v_and_b32 v87, 0xffff0000, v57
  v_lshlrev_b32 v88, 16, v58
  v_and_b32 v89, 0xffff0000, v58
  v_lshlrev_b32 v90, 16, v59
  v_and_b32 v91, 0xffff0000, v59
  v_mul_f32 v84, s77, v84
  v_mul_f32 v85, s77, v85
  v_mul_f32 v86, s77, v86
  v_mul_f32 v87, s77, v87
  v_mul_f32 v88, s77, v88
  v_mul_f32 v89, s77, v89
  v_mul_f32 v90, s77, v90
  v_mul_f32 v91, s77, v91
  v_cvt_pk_bf16_f32 v56, v84, v85
  v_cvt_pk_bf16_f32 v57, v86, v87
  v_cvt_pk_bf16_f32 v58, v88, v89
  v_cvt_pk_bf16_f32 v59, v90, v91
  v_lshlrev_b32 v84, 16, v56
  v_and_b32 v85, 0xffff0000, v56
  v_lshlrev_b32 v86, 16, v57
  v_and_b32 v87, 0xffff0000, v57
  v_lshlrev_b32 v88, 16, v58
  v_and_b32 v89, 0xffff0000, v58
  v_lshlrev_b32 v90, 16, v59
  v_and_b32 v91, 0xffff0000, v59
  v_max3_f32 v52, v84, v85, v86
  v_max3_f32 v53, v87, v88, v89
  v_max3_f32 v52, v52, v90, v91
  v_max_f32 v52, v52, v53
  v_mov_b32 v53, v52
  s_nop 1
  v_permlane32_swap_b32 v52, v53
  v_max_f32 v52, v52, v53
  v_mov_b32 v53, v52
  s_nop 1
  v_permlane16_swap_b32 v52, v53
  v_max_f32 v52, v52, v53
  v_cmp_gt_f32 vcc, v52, v24
  s_nop 0
  s_cbranch_vccz L_norescale_22
  v_max_f32 v52, v52, v24
  v_sub_f32 v53, v24, v52
  v_mul_f32 v53, s64, v53
  v_exp_f32 v53, v53
  v_mov_b32 v24, v52
  v_mul_f32 v26, s64, v52
  v_mul_f32 v25, v25, v53
  v_mul_f32 v160, v160, v53
  v_mul_f32 v161, v161, v53
  v_mul_f32 v162, v162, v53
  v_mul_f32 v163, v163, v53
  v_mul_f32 v164, v164, v53
  v_mul_f32 v165, v165, v53
  v_mul_f32 v166, v166, v53
  v_mul_f32 v167, v167, v53
  v_mul_f32 v168, v168, v53
  v_mul_f32 v169, v169, v53
  v_mul_f32 v170, v170, v53
  v_mul_f32 v171, v171, v53
  v_mul_f32 v172, v172, v53
  v_mul_f32 v173, v173, v53
  v_mul_f32 v174, v174, v53
  v_mul_f32 v175, v175, v53
  v_mul_f32 v176, v176, v53
  v_mul_f32 v177, v177, v53
  v_mul_f32 v178, v178, v53
  v_mul_f32 v179, v179, v53
  v_mul_f32 v180, v180, v53
  v_mul_f32 v181, v181, v53
  v_mul_f32 v182, v182, v53
  v_mul_f32 v183, v183, v53
  v_mul_f32 v184, v184, v53
  v_mul_f32 v185, v185, v53
  v_mul_f32 v186, v186, v53
  v_mul_f32 v187, v187, v53
  v_mul_f32 v188, v188, v53
  v_mul_f32 v189, v189, v53
  v_mul_f32 v190, v190, v53
  v_mul_f32 v191, v191, v53
L_norescale_22:
  v_fma_f32 v84, v84, s64, -v26
  v_fma_f32 v85, v85, s64, -v26
  v_fma_f32 v86, v86, s64, -v26
  v_fma_f32 v87, v87, s64, -v26
  v_fma_f32 v88, v88, s64, -v26
  v_fma_f32 v89, v89, s64, -v26
  v_fma_f32 v90, v90, s64, -v26
  v_fma_f32 v91, v91, s64, -v26
  v_exp_f32 v84, v84
  v_exp_f32 v85, v85
  v_exp_f32 v86, v86
  v_exp_f32 v87, v87
  v_exp_f32 v88, v88
  v_exp_f32 v89, v89
  v_exp_f32 v90, v90
  v_exp_f32 v91, v91
  v_add_f32 v52, v84, v85
  v_add_f32 v53, v86, v87
  v_cvt_pk_bf16_f32 v92, v84, v85
  v_cvt_pk_bf16_f32 v93, v86, v87
  v_cvt_pk_bf16_f32 v94, v88, v89
  v_cvt_pk_bf16_f32 v95, v90, v91
  v_add_f32 v52, v52, v88
  v_add_f32 v53, v53, v89
  v_add_f32 v52, v52, v90
  v_add_f32 v53, v53, v91
  v_add_f32 v52, v52, v53
  v_add_f32 v25, v25, v52
  s_waitcnt vmcnt(0)
  v_readfirstlane_b32 s68, v22
  s_nop 0
  s_add_u32 s68, s68, 192
  s_cmp_ge_u32 s68, 1024
  s_cbranch_scc1 L_finv0
  s_add_u32 s56, s68, s76
  s_and_b32 s56, s56, 1023
  s_lshl_b32 s56, s56, 13
  s_add_u32 m0, s53, 16384
  s_add_u32 s56, s56, s54
  buffer_load_dwordx4 v2, s[4:7], s56 offen offset:0 nt lds
  buffer_load_dwordx4 v3, s[4:7], s56 offen offset:1024 nt lds
  buffer_load_dwordx4 v4, s[4:7], s56 offen offset:2048 nt lds
  buffer_load_dwordx4 v5, s[4:7], s56 offen offset:3072 nt lds
  s_add_u32 m0, s53, 20480
  s_add_u32 s56, s56, 4096
  buffer_load_dwordx4 v2, s[4:7], s56 offen offset:0 nt lds
  buffer_load_dwordx4 v3, s[4:7], s56 offen offset:1024 nt lds
  buffer_load_dwordx4 v4, s[4:7], s56 offen offset:2048 nt lds
  buffer_load_dwordx4 v5, s[4:7], s56 offen offset:3072 nt lds
  ds_read_b64_tr_b16 v[128:129], v12 offset:8192
  ds_read_b64_tr_b16 v[130:131], v12 offset:12288
  ds_read_b64_tr_b16 v[132:133], v13 offset:8192
  ds_read_b64_tr_b16 v[134:135], v13 offset:12288
  ds_read_b64_tr_b16 v[136:137], v14 offset:8192
  ds_read_b64_tr_b16 v[138:139], v14 offset:12288
  ds_read_b64_tr_b16 v[140:141], v15 offset:8192
  ds_read_b64_tr_b16 v[142:143], v15 offset:12288
  ds_read_b64_tr_b16 v[144:145], v16 offset:8192
  ds_read_b64_tr_b16 v[146:147], v16 offset:12288
  ds_read_b64_tr_b16 v[148:149], v17 offset:8192
  ds_read_b64_tr_b16 v[150:151], v17 offset:12288
  ds_read_b64_tr_b16 v[152:153], v18 offset:8192
  ds_read_b64_tr_b16 v[154:155], v18 offset:12288
  s_waitcnt lgkmcnt(12)
  v_mfma_f32_16x16x32_bf16 v[160:163], v[128:131], v[92:95], v[160:163]
  ds_read_b64_tr_b16 v[156:157], v19 offset:8192
  ds_read_b64_tr_b16 v[158:159], v19 offset:12288
  s_waitcnt lgkmcnt(12)
  v_mfma_f32_16x16x32_bf16 v[164:167], v[132:135], v[92:95], v[164:167]
  s_waitcnt lgkmcnt(10)
  v_mfma_f32_16x16x32_bf16 v[168:171], v[136:139], v[92:95], v[168:171]
  s_waitcnt lgkmcnt(8)
  v_mfma_f32_16x16x32_bf16 v[172:175], v[140:143], v[92:95], v[172:175]
  s_waitcnt lgkmcnt(6)
  v_mfma_f32_16x16x32_bf16 v[176:179], v[144:147], v[92:95], v[176:179]
  s_waitcnt lgkmcnt(4)
  v_mfma_f32_16x16x32_bf16 v[180:183], v[148:151], v[92:95], v[180:183]
  s_waitcnt lgkmcnt(2)
  v_mfma_f32_16x16x32_bf16 v[184:187], v[152:155], v[92:95], v[184:187]
  s_waitcnt lgkmcnt(0)
  v_mfma_f32_16x16x32_bf16 v[188:191], v[156:159], v[92:95], v[188:191]
  s_add_u32 s56, s68, s76
  s_and_b32 s56, s56, 1023
  s_lshl_b32 s56, s56, 13
  s_add_u32 m0, s53, 24576
  s_add_u32 s56, s56, s54
  buffer_load_dwordx4 v6, s[8:11], s56 offen offset:0 nt lds
  buffer_load_dwordx4 v7, s[8:11], s56 offen offset:1024 nt lds
  buffer_load_dwordx4 v6, s[8:11], s56 offen offset:2048 nt lds
  buffer_load_dwordx4 v7, s[8:11], s56 offen offset:3072 nt lds
  s_add_u32 m0, s53, 28672
  s_add_u32 s56, s56, 4096
  buffer_load_dwordx4 v6, s[8:11], s56 offen offset:0 nt lds
  buffer_load_dwordx4 v7, s[8:11], s56 offen offset:1024 nt lds
  buffer_load_dwordx4 v6, s[8:11], s56 offen offset:2048 nt lds
  buffer_load_dwordx4 v7, s[8:11], s56 offen offset:3072 nt lds
  s_cmp_ge_u32 s68, 832
  s_cbranch_scc1 L_enter1
L_body1:
  s_waitcnt vmcnt(8)
  s_mov_b64 exec, 1
  v_mov_b32 v22, 1
  buffer_atomic_add v22, v23, s[12:15], s57 offen sc0
  s_mov_b64 exec, -1
  ds_read_b128 v[96:99], v8 offset:16384
  ds_read_b128 v[112:115], v8 offset:20480
  ds_read_b128 v[100:103], v9 offset:16384
  ds_read_b128 v[116:119], v9 offset:20480
  ds_read_b128 v[104:107], v10 offset:16384
  ds_read_b128 v[120:123], v10 offset:20480
  ds_read_b128 v[108:111], v11 offset:16384
  ds_read_b128 v[124:127], v11 offset:20480
  s_waitcnt lgkmcnt(6)
  v_mfma_f32_16x16x32_bf16 v[84:87], v[96:99], v[68:71], 0
  v_mfma_f32_16x16x32_bf16 v[88:91], v[112:115], v[68:71], 0
  s_waitcnt lgkmcnt(4)
  v_mfma_f32_16x16x32_bf16 v[84:87], v[100:103], v[72:75], v[84:87]
  v_mfma_f32_16x16x32_bf16 v[88:91], v[116:119], v[72:75], v[88:91]
  s_waitcnt lgkmcnt(2)
  v_mfma_f32_16x16x32_bf16 v[84:87], v[104:107], v[76:79], v[84:87]
  v_mfma_f32_16x16x32_bf16 v[88:91], v[120:123], v[76:79], v[88:91]
  s_waitcnt lgkmcnt(0)
  v_mfma_f32_16x16x32_bf16 v[84:87], v[108:111], v[80:83], v[84:87]
  v_mfma_f32_16x16x32_bf16 v[88:91], v[124:127], v[80:83], v[88:91]
  s_nop 6
  v_cvt_pk_bf16_f32 v56, v84, v85
  v_cvt_pk_bf16_f32 v57, v86, v87
  v_cvt_pk_bf16_f32 v58, v88, v89
  v_cvt_pk_bf16_f32 v59, v90, v91
  v_lshlrev_b32 v84, 16, v56
  v_and_b32 v85, 0xffff0000, v56
  v_lshlrev_b32 v86, 16, v57
  v_and_b32 v87, 0xffff0000, v57
  v_lshlrev_b32 v88, 16, v58
  v_and_b32 v89, 0xffff0000, v58
  v_lshlrev_b32 v90, 16, v59
  v_and_b32 v91, 0xffff0000, v59
  v_mul_f32 v84, s77, v84
  v_mul_f32 v85, s77, v85
  v_mul_f32 v86, s77, v86
  v_mul_f32 v87, s77, v87
  v_mul_f32 v88, s77, v88
  v_mul_f32 v89, s77, v89
  v_mul_f32 v90, s77, v90
  v_mul_f32 v91, s77, v91
  v_cvt_pk_bf16_f32 v56, v84, v85
  v_cvt_pk_bf16_f32 v57, v86, v87
  v_cvt_pk_bf16_f32 v58, v88, v89
  v_cvt_pk_bf16_f32 v59, v90, v91
  v_lshlrev_b32 v84, 16, v56
  v_and_b32 v85, 0xffff0000, v56
  v_lshlrev_b32 v86, 16, v57
  v_and_b32 v87, 0xffff0000, v57
  v_lshlrev_b32 v88, 16, v58
  v_and_b32 v89, 0xffff0000, v58
  v_lshlrev_b32 v90, 16, v59
  v_and_b32 v91, 0xffff0000, v59
  v_max3_f32 v52, v84, v85, v86
  v_max3_f32 v53, v87, v88, v89
  v_max3_f32 v52, v52, v90, v91
  v_max_f32 v52, v52, v53
  v_mov_b32 v53, v52
  s_nop 1
  v_permlane32_swap_b32 v52, v53
  v_max_f32 v52, v52, v53
  v_mov_b32 v53, v52
  s_nop 1
  v_permlane16_swap_b32 v52, v53
  v_max_f32 v52, v52, v53
  v_cmp_gt_f32 vcc, v52, v24
  s_nop 0
  s_cbranch_vccz L_norescale_23
  v_max_f32 v52, v52, v24
  v_sub_f32 v53, v24, v52
  v_mul_f32 v53, s64, v53
  v_exp_f32 v53, v53
  v_mov_b32 v24, v52
  v_mul_f32 v26, s64, v52
  v_mul_f32 v25, v25, v53
  v_mul_f32 v160, v160, v53
  v_mul_f32 v161, v161, v53
  v_mul_f32 v162, v162, v53
  v_mul_f32 v163, v163, v53
  v_mul_f32 v164, v164, v53
  v_mul_f32 v165, v165, v53
  v_mul_f32 v166, v166, v53
  v_mul_f32 v167, v167, v53
  v_mul_f32 v168, v168, v53
  v_mul_f32 v169, v169, v53
  v_mul_f32 v170, v170, v53
  v_mul_f32 v171, v171, v53
  v_mul_f32 v172, v172, v53
  v_mul_f32 v173, v173, v53
  v_mul_f32 v174, v174, v53
  v_mul_f32 v175, v175, v53
  v_mul_f32 v176, v176, v53
  v_mul_f32 v177, v177, v53
  v_mul_f32 v178, v178, v53
  v_mul_f32 v179, v179, v53
  v_mul_f32 v180, v180, v53
  v_mul_f32 v181, v181, v53
  v_mul_f32 v182, v182, v53
  v_mul_f32 v183, v183, v53
  v_mul_f32 v184, v184, v53
  v_mul_f32 v185, v185, v53
  v_mul_f32 v186, v186, v53
  v_mul_f32 v187, v187, v53
  v_mul_f32 v188, v188, v53
  v_mul_f32 v189, v189, v53
  v_mul_f32 v190, v190, v53
  v_mul_f32 v191, v191, v53
L_norescale_23:
  v_fma_f32 v84, v84, s64, -v26
  v_fma_f32 v85, v85, s64, -v26
  v_fma_f32 v86, v86, s64, -v26
  v_fma_f32 v87, v87, s64, -v26
  v_fma_f32 v88, v88, s64, -v26
  v_fma_f32 v89, v89, s64, -v26
  v_fma_f32 v90, v90, s64, -v26
  v_fma_f32 v91, v91, s64, -v26
  v_exp_f32 v84, v84
  v_exp_f32 v85, v85
  v_exp_f32 v86, v86
  v_exp_f32 v87, v87
  v_exp_f32 v88, v88
  v_exp_f32 v89, v89
  v_exp_f32 v90, v90
  v_exp_f32 v91, v91
  v_add_f32 v52, v84, v85
  v_add_f32 v53, v86, v87
  v_cvt_pk_bf16_f32 v92, v84, v85
  v_cvt_pk_bf16_f32 v93, v86, v87
  v_cvt_pk_bf16_f32 v94, v88, v89
  v_cvt_pk_bf16_f32 v95, v90, v91
  v_add_f32 v52, v52, v88
  v_add_f32 v53, v53, v89
  v_add_f32 v52, v52, v90
  v_add_f32 v53, v53, v91
  v_add_f32 v52, v52, v53
  v_add_f32 v25, v25, v52
  s_waitcnt vmcnt(0)
  v_readfirstlane_b32 s68, v22
  s_nop 0
  s_add_u32 s68, s68, 192
  s_cmp_ge_u32 s68, 1024
  s_cbranch_scc1 L_finv1
  s_add_u32 s56, s68, s76
  s_and_b32 s56, s56, 1023
  s_lshl_b32 s56, s56, 13
  s_add_u32 m0, s53, 0
  s_add_u32 s56, s56, s54
  buffer_load_dwordx4 v2, s[4:7], s56 offen offset:0 nt lds
  buffer_load_dwordx4 v3, s[4:7], s56 offen offset:1024 nt lds
  buffer_load_dwordx4 v4, s[4:7], s56 offen offset:2048 nt lds
  buffer_load_dwordx4 v5, s[4:7], s56 offen offset:3072 nt lds
  s_add_u32 m0, s53, 4096
  s_add_u32 s56, s56, 4096
  buffer_load_dwordx4 v2, s[4:7], s56 offen offset:0 nt lds
  buffer_load_dwordx4 v3, s[4:7], s56 offen offset:1024 nt lds
  buffer_load_dwordx4 v4, s[4:7], s56 offen offset:2048 nt lds
  buffer_load_dwordx4 v5, s[4:7], s56 offen offset:3072 nt lds
  ds_read_b64_tr_b16 v[128:129], v12 offset:24576
  ds_read_b64_tr_b16 v[130:131], v12 offset:28672
  ds_read_b64_tr_b16 v[132:133], v13 offset:24576
  ds_read_b64_tr_b16 v[134:135], v13 offset:28672
  ds_read_b64_tr_b16 v[136:137], v14 offset:24576
  ds_read_b64_tr_b16 v[138:139], v14 offset:28672
  ds_read_b64_tr_b16 v[140:141], v15 offset:24576
  ds_read_b64_tr_b16 v[142:143], v15 offset:28672
  ds_read_b64_tr_b16 v[144:145], v16 offset:24576
  ds_read_b64_tr_b16 v[146:147], v16 offset:28672
  ds_read_b64_tr_b16 v[148:149], v17 offset:24576
  ds_read_b64_tr_b16 v[150:151], v17 offset:28672
  ds_read_b64_tr_b16 v[152:153], v18 offset:24576
  ds_read_b64_tr_b16 v[154:155], v18 offset:28672
  s_waitcnt lgkmcnt(12)
  v_mfma_f32_16x16x32_bf16 v[160:163], v[128:131], v[92:95], v[160:163]
  ds_read_b64_tr_b16 v[156:157], v19 offset:24576
  ds_read_b64_tr_b16 v[158:159], v19 offset:28672
  s_waitcnt lgkmcnt(12)
  v_mfma_f32_16x16x32_bf16 v[164:167], v[132:135], v[92:95], v[164:167]
  s_waitcnt lgkmcnt(10)
  v_mfma_f32_16x16x32_bf16 v[168:171], v[136:139], v[92:95], v[168:171]
  s_waitcnt lgkmcnt(8)
  v_mfma_f32_16x16x32_bf16 v[172:175], v[140:143], v[92:95], v[172:175]
  s_waitcnt lgkmcnt(6)
  v_mfma_f32_16x16x32_bf16 v[176:179], v[144:147], v[92:95], v[176:179]
  s_waitcnt lgkmcnt(4)
  v_mfma_f32_16x16x32_bf16 v[180:183], v[148:151], v[92:95], v[180:183]
  s_waitcnt lgkmcnt(2)
  v_mfma_f32_16x16x32_bf16 v[184:187], v[152:155], v[92:95], v[184:187]
  s_waitcnt lgkmcnt(0)
  v_mfma_f32_16x16x32_bf16 v[188:191], v[156:159], v[92:95], v[188:191]
  s_add_u32 s56, s68, s76
  s_and_b32 s56, s56, 1023
  s_lshl_b32 s56, s56, 13
  s_add_u32 m0, s53, 8192
  s_add_u32 s56, s56, s54
  buffer_load_dwordx4 v6, s[8:11], s56 offen offset:0 nt lds
  buffer_load_dwordx4 v7, s[8:11], s56 offen offset:1024 nt lds
  buffer_load_dwordx4 v6, s[8:11], s56 offen offset:2048 nt lds
  buffer_load_dwordx4 v7, s[8:11], s56 offen offset:3072 nt lds
  s_add_u32 m0, s53, 12288
  s_add_u32 s56, s56, 4096
  buffer_load_dwordx4 v6, s[8:11], s56 offen offset:0 nt lds
  buffer_load_dwordx4 v7, s[8:11], s56 offen offset:1024 nt lds
  buffer_load_dwordx4 v6, s[8:11], s56 offen offset:2048 nt lds
  buffer_load_dwordx4 v7, s[8:11], s56 offen offset:3072 nt lds
  s_cmp_ge_u32 s68, 832
  s_cbranch_scc1 L_enter0
  s_branch L_loop
L_enter0:
  s_cmp_ge_u32 s68, 992
  s_cbranch_scc1 L_dlast0
  s_mov_b64 exec, 1
  v_mov_b32 v22, 1
  buffer_atomic_add v22, v23, s[12:15], s57 offen sc0
  s_mov_b64 exec, -1
  s_branch L_drain0
L_enter1:
  s_cmp_ge_u32 s68, 992
  s_cbranch_scc1 L_dlast1
  s_mov_b64 exec, 1
  v_mov_b32 v22, 1
  buffer_atomic_add v22, v23, s[12:15], s57 offen sc0
  s_mov_b64 exec, -1
  s_branch L_drain1
L_drain0:
  s_waitcnt vmcnt(9)
  ds_read_b128 v[96:99], v8 offset:0
  ds_read_b128 v[112:115], v8 offset:4096
  ds_read_b128 v[100:103], v9 offset:0
  ds_read_b128 v[116:119], v9 offset:4096
  ds_read_b128 v[104:107], v10 offset:0
  ds_read_b128 v[120:123], v10 offset:4096
  ds_read_b128 v[108:111], v11 offset:0
  ds_read_b128 v[124:127], v11 offset:4096
  s_waitcnt lgkmcnt(6)
  v_mfma_f32_16x16x32_bf16 v[84:87], v[96:99], v[68:71], 0
  v_mfma_f32_16x16x32_bf16 v[88:91], v[112:115], v[68:71], 0
  s_waitcnt lgkmcnt(4)
  v_mfma_f32_16x16x32_bf16 v[84:87], v[100:103], v[72:75], v[84:87]
  v_mfma_f32_16x16x32_bf16 v[88:91], v[116:119], v[72:75], v[88:91]
  s_waitcnt lgkmcnt(2)
  v_mfma_f32_16x16x32_bf16 v[84:87], v[104:107], v[76:79], v[84:87]
  v_mfma_f32_16x16x32_bf16 v[88:91], v[120:123], v[76:79], v[88:91]
  s_waitcnt lgkmcnt(0)
  v_mfma_f32_16x16x32_bf16 v[84:87], v[108:111], v[80:83], v[84:87]
  v_mfma_f32_16x16x32_bf16 v[88:91], v[124:127], v[80:83], v[88:91]
  s_nop 6
  v_cvt_pk_bf16_f32 v56, v84, v85
  v_cvt_pk_bf16_f32 v57, v86, v87
  v_cvt_pk_bf16_f32 v58, v88, v89
  v_cvt_pk_bf16_f32 v59, v90, v91
  v_lshlrev_b32 v84, 16, v56
  v_and_b32 v85, 0xffff0000, v56
  v_lshlrev_b32 v86, 16, v57
  v_and_b32 v87, 0xffff0000, v57
  v_lshlrev_b32 v88, 16, v58
  v_and_b32 v89, 0xffff0000, v58
  v_lshlrev_b32 v90, 16, v59
  v_and_b32 v91, 0xffff0000, v59
  v_mul_f32 v84, s77, v84
  v_mul_f32 v85, s77, v85
  v_mul_f32 v86, s77, v86
  v_mul_f32 v87, s77, v87
  v_mul_f32 v88, s77, v88
  v_mul_f32 v89, s77, v89
  v_mul_f32 v90, s77, v90
  v_mul_f32 v91, s77, v91
  v_cvt_pk_bf16_f32 v56, v84, v85
  v_cvt_pk_bf16_f32 v57, v86, v87
  v_cvt_pk_bf16_f32 v58, v88, v89
  v_cvt_pk_bf16_f32 v59, v90, v91
  v_lshlrev_b32 v84, 16, v56
  v_and_b32 v85, 0xffff0000, v56
  v_lshlrev_b32 v86, 16, v57
  v_and_b32 v87, 0xffff0000, v57
  v_lshlrev_b32 v88, 16, v58
  v_and_b32 v89, 0xffff0000, v58
  v_lshlrev_b32 v90, 16, v59
  v_and_b32 v91, 0xffff0000, v59
  v_max3_f32 v52, v84, v85, v86
  v_max3_f32 v53, v87, v88, v89
  v_max3_f32 v52, v52, v90, v91
  v_max_f32 v52, v52, v53
  v_mov_b32 v53, v52
  s_nop 1
  v_permlane32_swap_b32 v52, v53
  v_max_f32 v52, v52, v53
  v_mov_b32 v53, v52
  s_nop 1
  v_permlane16_swap_b32 v52, v53
  v_max_f32 v52, v52, v53
  v_cmp_gt_f32 vcc, v52, v24
  s_nop 0
  s_cbranch_vccz L_norescale_24
  v_max_f32 v52, v52, v24
  v_sub_f32 v53, v24, v52
  v_mul_f32 v53, s64, v53
  v_exp_f32 v53, v53
  v_mov_b32 v24, v52
  v_mul_f32 v26, s64, v52
  v_mul_f32 v25, v25, v53
  v_mul_f32 v160, v160, v53
  v_mul_f32 v161, v161, v53
  v_mul_f32 v162, v162, v53
  v_mul_f32 v163, v163, v53
  v_mul_f32 v164, v164, v53
  v_mul_f32 v165, v165, v53
  v_mul_f32 v166, v166, v53
  v_mul_f32 v167, v167, v53
  v_mul_f32 v168, v168, v53
  v_mul_f32 v169, v169, v53
  v_mul_f32 v170, v170, v53
  v_mul_f32 v171, v171, v53
  v_mul_f32 v172, v172, v53
  v_mul_f32 v173, v173, v53
  v_mul_f32 v174, v174, v53
  v_mul_f32 v175, v175, v53
  v_mul_f32 v176, v176, v53
  v_mul_f32 v177, v177, v53
  v_mul_f32 v178, v178, v53
  v_mul_f32 v179, v179, v53
  v_mul_f32 v180, v180, v53
  v_mul_f32 v181, v181, v53
  v_mul_f32 v182, v182, v53
  v_mul_f32 v183, v183, v53
  v_mul_f32 v184, v184, v53
  v_mul_f32 v185, v185, v53
  v_mul_f32 v186, v186, v53
  v_mul_f32 v187, v187, v53
  v_mul_f32 v188, v188, v53
  v_mul_f32 v189, v189, v53
  v_mul_f32 v190, v190, v53
  v_mul_f32 v191, v191, v53
L_norescale_24:
  v_fma_f32 v84, v84, s64, -v26
  v_fma_f32 v85, v85, s64, -v26
  v_fma_f32 v86, v86, s64, -v26
  v_fma_f32 v87, v87, s64, -v26
  v_fma_f32 v88, v88, s64, -v26
  v_fma_f32 v89, v89, s64, -v26
  v_fma_f32 v90, v90, s64, -v26
  v_fma_f32 v91, v91, s64, -v26
  v_exp_f32 v84, v84
  v_exp_f32 v85, v85
  v_exp_f32 v86, v86
  v_exp_f32 v87, v87
  v_exp_f32 v88, v88
  v_exp_f32 v89, v89
  v_exp_f32 v90, v90
  v_exp_f32 v91, v91
  v_add_f32 v52, v84, v85
  v_add_f32 v53, v86, v87
  v_cvt_pk_bf16_f32 v92, v84, v85
  v_cvt_pk_bf16_f32 v93, v86, v87
  v_cvt_pk_bf16_f32 v94, v88, v89
  v_cvt_pk_bf16_f32 v95, v90, v91
  v_add_f32 v52, v52, v88
  v_add_f32 v53, v53, v89
  v_add_f32 v52, v52, v90
  v_add_f32 v53, v53, v91
  v_add_f32 v52, v52, v53
  v_add_f32 v25, v25, v52
  s_waitcnt vmcnt(0)
  v_readfirstlane_b32 s68, v22
  s_nop 0
  s_add_u32 s68, s68, 192
  s_cmp_ge_u32 s68, 1024
  s_cbranch_scc1 L_finv0
  s_add_u32 s56, s68, s76
  s_and_b32 s56, s56, 1023
  s_lshl_b32 s56, s56, 13
  s_add_u32 m0, s53, 16384
  s_add_u32 s56, s56, s54
  buffer_load_dwordx4 v2, s[4:7], s56 offen offset:0 nt lds
  buffer_load_dwordx4 v3, s[4:7], s56 offen offset:1024 nt lds
  buffer_load_dwordx4 v4, s[4:7], s56 offen offset:2048 nt lds
  buffer_load_dwordx4 v5, s[4:7], s56 offen offset:3072 nt lds
  s_add_u32 m0, s53, 20480
  s_add_u32 s56, s56, 4096
  buffer_load_dwordx4 v2, s[4:7], s56 offen offset:0 nt lds
  buffer_load_dwordx4 v3, s[4:7], s56 offen offset:1024 nt lds
  buffer_load_dwordx4 v4, s[4:7], s56 offen offset:2048 nt lds
  buffer_load_dwordx4 v5, s[4:7], s56 offen offset:3072 nt lds
  ds_read_b64_tr_b16 v[128:129], v12 offset:8192
  ds_read_b64_tr_b16 v[130:131], v12 offset:12288
  ds_read_b64_tr_b16 v[132:133], v13 offset:8192
  ds_read_b64_tr_b16 v[134:135], v13 offset:12288
  ds_read_b64_tr_b16 v[136:137], v14 offset:8192
  ds_read_b64_tr_b16 v[138:139], v14 offset:12288
  ds_read_b64_tr_b16 v[140:141], v15 offset:8192
  ds_read_b64_tr_b16 v[142:143], v15 offset:12288
  ds_read_b64_tr_b16 v[144:145], v16 offset:8192
  ds_read_b64_tr_b16 v[146:147], v16 offset:12288
  ds_read_b64_tr_b16 v[148:149], v17 offset:8192
  ds_read_b64_tr_b16 v[150:151], v17 offset:12288
  ds_read_b64_tr_b16 v[152:153], v18 offset:8192
  ds_read_b64_tr_b16 v[154:155], v18 offset:12288
  s_waitcnt lgkmcnt(12)
  v_mfma_f32_16x16x32_bf16 v[160:163], v[128:131], v[92:95], v[160:163]
  ds_read_b64_tr_b16 v[156:157], v19 offset:8192
  ds_read_b64_tr_b16 v[158:159], v19 offset:12288
  s_waitcnt lgkmcnt(12)
  v_mfma_f32_16x16x32_bf16 v[164:167], v[132:135], v[92:95], v[164:167]
  s_waitcnt lgkmcnt(10)
  v_mfma_f32_16x16x32_bf16 v[168:171], v[136:139], v[92:95], v[168:171]
  s_waitcnt lgkmcnt(8)
  v_mfma_f32_16x16x32_bf16 v[172:175], v[140:143], v[92:95], v[172:175]
  s_waitcnt lgkmcnt(6)
  v_mfma_f32_16x16x32_bf16 v[176:179], v[144:147], v[92:95], v[176:179]
  s_waitcnt lgkmcnt(4)
  v_mfma_f32_16x16x32_bf16 v[180:183], v[148:151], v[92:95], v[180:183]
  s_waitcnt lgkmcnt(2)
  v_mfma_f32_16x16x32_bf16 v[184:187], v[152:155], v[92:95], v[184:187]
  s_waitcnt lgkmcnt(0)
  v_mfma_f32_16x16x32_bf16 v[188:191], v[156:159], v[92:95], v[188:191]
  s_add_u32 s56, s68, s76
  s_and_b32 s56, s56, 1023
  s_lshl_b32 s56, s56, 13
  s_add_u32 m0, s53, 24576
  s_add_u32 s56, s56, s54
  buffer_load_dwordx4 v6, s[8:11], s56 offen offset:0 nt lds
  buffer_load_dwordx4 v7, s[8:11], s56 offen offset:1024 nt lds
  buffer_load_dwordx4 v6, s[8:11], s56 offen offset:2048 nt lds
  buffer_load_dwordx4 v7, s[8:11], s56 offen offset:3072 nt lds
  s_add_u32 m0, s53, 28672
  s_add_u32 s56, s56, 4096
  buffer_load_dwordx4 v6, s[8:11], s56 offen offset:0 nt lds
  buffer_load_dwordx4 v7, s[8:11], s56 offen offset:1024 nt lds
  buffer_load_dwordx4 v6, s[8:11], s56 offen offset:2048 nt lds
  buffer_load_dwordx4 v7, s[8:11], s56 offen offset:3072 nt lds
  s_cmp_ge_u32 s68, 992
  s_cbranch_scc1 L_dlast1
  s_mov_b64 exec, 1
  v_mov_b32 v22, 1
  buffer_atomic_add v22, v23, s[12:15], s57 offen sc0
  s_mov_b64 exec, -1
L_drain1:
  s_waitcnt vmcnt(9)
  ds_read_b128 v[96:99], v8 offset:16384
  ds_read_b128 v[112:115], v8 offset:20480
  ds_read_b128 v[100:103], v9 offset:16384
  ds_read_b128 v[116:119], v9 offset:20480
  ds_read_b128 v[104:107], v10 offset:16384
  ds_read_b128 v[120:123], v10 offset:20480
  ds_read_b128 v[108:111], v11 offset:16384
  ds_read_b128 v[124:127], v11 offset:20480
  s_waitcnt lgkmcnt(6)
  v_mfma_f32_16x16x32_bf16 v[84:87], v[96:99], v[68:71], 0
  v_mfma_f32_16x16x32_bf16 v[88:91], v[112:115], v[68:71], 0
  s_waitcnt lgkmcnt(4)
  v_mfma_f32_16x16x32_bf16 v[84:87], v[100:103], v[72:75], v[84:87]
  v_mfma_f32_16x16x32_bf16 v[88:91], v[116:119], v[72:75], v[88:91]
  s_waitcnt lgkmcnt(2)
  v_mfma_f32_16x16x32_bf16 v[84:87], v[104:107], v[76:79], v[84:87]
  v_mfma_f32_16x16x32_bf16 v[88:91], v[120:123], v[76:79], v[88:91]
  s_waitcnt lgkmcnt(0)
  v_mfma_f32_16x16x32_bf16 v[84:87], v[108:111], v[80:83], v[84:87]
  v_mfma_f32_16x16x32_bf16 v[88:91], v[124:127], v[80:83], v[88:91]
  s_nop 6
  v_cvt_pk_bf16_f32 v56, v84, v85
  v_cvt_pk_bf16_f32 v57, v86, v87
  v_cvt_pk_bf16_f32 v58, v88, v89
  v_cvt_pk_bf16_f32 v59, v90, v91
  v_lshlrev_b32 v84, 16, v56
  v_and_b32 v85, 0xffff0000, v56
  v_lshlrev_b32 v86, 16, v57
  v_and_b32 v87, 0xffff0000, v57
  v_lshlrev_b32 v88, 16, v58
  v_and_b32 v89, 0xffff0000, v58
  v_lshlrev_b32 v90, 16, v59
  v_and_b32 v91, 0xffff0000, v59
  v_mul_f32 v84, s77, v84
  v_mul_f32 v85, s77, v85
  v_mul_f32 v86, s77, v86
  v_mul_f32 v87, s77, v87
  v_mul_f32 v88, s77, v88
  v_mul_f32 v89, s77, v89
  v_mul_f32 v90, s77, v90
  v_mul_f32 v91, s77, v91
  v_cvt_pk_bf16_f32 v56, v84, v85
  v_cvt_pk_bf16_f32 v57, v86, v87
  v_cvt_pk_bf16_f32 v58, v88, v89
  v_cvt_pk_bf16_f32 v59, v90, v91
  v_lshlrev_b32 v84, 16, v56
  v_and_b32 v85, 0xffff0000, v56
  v_lshlrev_b32 v86, 16, v57
  v_and_b32 v87, 0xffff0000, v57
  v_lshlrev_b32 v88, 16, v58
  v_and_b32 v89, 0xffff0000, v58
  v_lshlrev_b32 v90, 16, v59
  v_and_b32 v91, 0xffff0000, v59
  v_max3_f32 v52, v84, v85, v86
  v_max3_f32 v53, v87, v88, v89
  v_max3_f32 v52, v52, v90, v91
  v_max_f32 v52, v52, v53
  v_mov_b32 v53, v52
  s_nop 1
  v_permlane32_swap_b32 v52, v53
  v_max_f32 v52, v52, v53
  v_mov_b32 v53, v52
  s_nop 1
  v_permlane16_swap_b32 v52, v53
  v_max_f32 v52, v52, v53
  v_cmp_gt_f32 vcc, v52, v24
  s_nop 0
  s_cbranch_vccz L_norescale_25
  v_max_f32 v52, v52, v24
  v_sub_f32 v53, v24, v52
  v_mul_f32 v53, s64, v53
  v_exp_f32 v53, v53
  v_mov_b32 v24, v52
  v_mul_f32 v26, s64, v52
  v_mul_f32 v25, v25, v53
  v_mul_f32 v160, v160, v53
  v_mul_f32 v161, v161, v53
  v_mul_f32 v162, v162, v53
  v_mul_f32 v163, v163, v53
  v_mul_f32 v164, v164, v53
  v_mul_f32 v165, v165, v53
  v_mul_f32 v166, v166, v53
  v_mul_f32 v167, v167, v53
  v_mul_f32 v168, v168, v53
  v_mul_f32 v169, v169, v53
  v_mul_f32 v170, v170, v53
  v_mul_f32 v171, v171, v53
  v_mul_f32 v172, v172, v53
  v_mul_f32 v173, v173, v53
  v_mul_f32 v174, v174, v53
  v_mul_f32 v175, v175, v53
  v_mul_f32 v176, v176, v53
  v_mul_f32 v177, v177, v53
  v_mul_f32 v178, v178, v53
  v_mul_f32 v179, v179, v53
  v_mul_f32 v180, v180, v53
  v_mul_f32 v181, v181, v53
  v_mul_f32 v182, v182, v53
  v_mul_f32 v183, v183, v53
  v_mul_f32 v184, v184, v53
  v_mul_f32 v185, v185, v53
  v_mul_f32 v186, v186, v53
  v_mul_f32 v187, v187, v53
  v_mul_f32 v188, v188, v53
  v_mul_f32 v189, v189, v53
  v_mul_f32 v190, v190, v53
  v_mul_f32 v191, v191, v53
L_norescale_25:
  v_fma_f32 v84, v84, s64, -v26
  v_fma_f32 v85, v85, s64, -v26
  v_fma_f32 v86, v86, s64, -v26
  v_fma_f32 v87, v87, s64, -v26
  v_fma_f32 v88, v88, s64, -v26
  v_fma_f32 v89, v89, s64, -v26
  v_fma_f32 v90, v90, s64, -v26
  v_fma_f32 v91, v91, s64, -v26
  v_exp_f32 v84, v84
  v_exp_f32 v85, v85
  v_exp_f32 v86, v86
  v_exp_f32 v87, v87
  v_exp_f32 v88, v88
  v_exp_f32 v89, v89
  v_exp_f32 v90, v90
  v_exp_f32 v91, v91
  v_add_f32 v52, v84, v85
  v_add_f32 v53, v86, v87
  v_cvt_pk_bf16_f32 v92, v84, v85
  v_cvt_pk_bf16_f32 v93, v86, v87
  v_cvt_pk_bf16_f32 v94, v88, v89
  v_cvt_pk_bf16_f32 v95, v90, v91
  v_add_f32 v52, v52, v88
  v_add_f32 v53, v53, v89
  v_add_f32 v52, v52, v90
  v_add_f32 v53, v53, v91
  v_add_f32 v52, v52, v53
  v_add_f32 v25, v25, v52
  s_waitcnt vmcnt(0)
  v_readfirstlane_b32 s68, v22
  s_nop 0
  s_add_u32 s68, s68, 192
  s_cmp_ge_u32 s68, 1024
  s_cbranch_scc1 L_finv1
  s_add_u32 s56, s68, s76
  s_and_b32 s56, s56, 1023
  s_lshl_b32 s56, s56, 13
  s_add_u32 m0, s53, 0
  s_add_u32 s56, s56, s54
  buffer_load_dwordx4 v2, s[4:7], s56 offen offset:0 nt lds
  buffer_load_dwordx4 v3, s[4:7], s56 offen offset:1024 nt lds
  buffer_load_dwordx4 v4, s[4:7], s56 offen offset:2048 nt lds
  buffer_load_dwordx4 v5, s[4:7], s56 offen offset:3072 nt lds
  s_add_u32 m0, s53, 4096
  s_add_u32 s56, s56, 4096
  buffer_load_dwordx4 v2, s[4:7], s56 offen offset:0 nt lds
  buffer_load_dwordx4 v3, s[4:7], s56 offen offset:1024 nt lds
  buffer_load_dwordx4 v4, s[4:7], s56 offen offset:2048 nt lds
  buffer_load_dwordx4 v5, s[4:7], s56 offen offset:3072 nt lds
  ds_read_b64_tr_b16 v[128:129], v12 offset:24576
  ds_read_b64_tr_b16 v[130:131], v12 offset:28672
  ds_read_b64_tr_b16 v[132:133], v13 offset:24576
  ds_read_b64_tr_b16 v[134:135], v13 offset:28672
  ds_read_b64_tr_b16 v[136:137], v14 offset:24576
  ds_read_b64_tr_b16 v[138:139], v14 offset:28672
  ds_read_b64_tr_b16 v[140:141], v15 offset:24576
  ds_read_b64_tr_b16 v[142:143], v15 offset:28672
  ds_read_b64_tr_b16 v[144:145], v16 offset:24576
  ds_read_b64_tr_b16 v[146:147], v16 offset:28672
  ds_read_b64_tr_b16 v[148:149], v17 offset:24576
  ds_read_b64_tr_b16 v[150:151], v17 offset:28672
  ds_read_b64_tr_b16 v[152:153], v18 offset:24576
  ds_read_b64_tr_b16 v[154:155], v18 offset:28672
  s_waitcnt lgkmcnt(12)
  v_mfma_f32_16x16x32_bf16 v[160:163], v[128:131], v[92:95], v[160:163]
  ds_read_b64_tr_b16 v[156:157], v19 offset:24576
  ds_read_b64_tr_b16 v[158:159], v19 offset:28672
  s_waitcnt lgkmcnt(12)
  v_mfma_f32_16x16x32_bf16 v[164:167], v[132:135], v[92:95], v[164:167]
  s_waitcnt lgkmcnt(10)
  v_mfma_f32_16x16x32_bf16 v[168:171], v[136:139], v[92:95], v[168:171]
  s_waitcnt lgkmcnt(8)
  v_mfma_f32_16x16x32_bf16 v[172:175], v[140:143], v[92:95], v[172:175]
  s_waitcnt lgkmcnt(6)
  v_mfma_f32_16x16x32_bf16 v[176:179], v[144:147], v[92:95], v[176:179]
  s_waitcnt lgkmcnt(4)
  v_mfma_f32_16x16x32_bf16 v[180:183], v[148:151], v[92:95], v[180:183]
  s_waitcnt lgkmcnt(2)
  v_mfma_f32_16x16x32_bf16 v[184:187], v[152:155], v[92:95], v[184:187]
  s_waitcnt lgkmcnt(0)
  v_mfma_f32_16x16x32_bf16 v[188:191], v[156:159], v[92:95], v[188:191]
  s_add_u32 s56, s68, s76
  s_and_b32 s56, s56, 1023
  s_lshl_b32 s56, s56, 13
  s_add_u32 m0, s53, 8192
  s_add_u32 s56, s56, s54
  buffer_load_dwordx4 v6, s[8:11], s56 offen offset:0 nt lds
  buffer_load_dwordx4 v7, s[8:11], s56 offen offset:1024 nt lds
  buffer_load_dwordx4 v6, s[8:11], s56 offen offset:2048 nt lds
  buffer_load_dwordx4 v7, s[8:11], s56 offen offset:3072 nt lds
  s_add_u32 m0, s53, 12288
  s_add_u32 s56, s56, 4096
  buffer_load_dwordx4 v6, s[8:11], s56 offen offset:0 nt lds
  buffer_load_dwordx4 v7, s[8:11], s56 offen offset:1024 nt lds
  buffer_load_dwordx4 v6, s[8:11], s56 offen offset:2048 nt lds
  buffer_load_dwordx4 v7, s[8:11], s56 offen offset:3072 nt lds
  s_cmp_ge_u32 s68, 992
  s_cbranch_scc1 L_dlast0
  s_mov_b64 exec, 1
  v_mov_b32 v22, 1
  buffer_atomic_add v22, v23, s[12:15], s57 offen sc0
  s_mov_b64 exec, -1
  s_branch L_drain0
L_dlast0:
  s_waitcnt vmcnt(8)
  ds_read_b128 v[96:99], v8 offset:0
  ds_read_b128 v[112:115], v8 offset:4096
  ds_read_b128 v[100:103], v9 offset:0
  ds_read_b128 v[116:119], v9 offset:4096
  ds_read_b128 v[104:107], v10 offset:0
  ds_read_b128 v[120:123], v10 offset:4096
  ds_read_b128 v[108:111], v11 offset:0
  ds_read_b128 v[124:127], v11 offset:4096
  s_waitcnt lgkmcnt(6)
  v_mfma_f32_16x16x32_bf16 v[84:87], v[96:99], v[68:71], 0
  v_mfma_f32_16x16x32_bf16 v[88:91], v[112:115], v[68:71], 0
  s_waitcnt lgkmcnt(4)
  v_mfma_f32_16x16x32_bf16 v[84:87], v[100:103], v[72:75], v[84:87]
  v_mfma_f32_16x16x32_bf16 v[88:91], v[116:119], v[72:75], v[88:91]
  s_waitcnt lgkmcnt(2)
  v_mfma_f32_16x16x32_bf16 v[84:87], v[104:107], v[76:79], v[84:87]
  v_mfma_f32_16x16x32_bf16 v[88:91], v[120:123], v[76:79], v[88:91]
  s_waitcnt lgkmcnt(0)
  v_mfma_f32_16x16x32_bf16 v[84:87], v[108:111], v[80:83], v[84:87]
  v_mfma_f32_16x16x32_bf16 v[88:91], v[124:127], v[80:83], v[88:91]
  s_nop 6
  v_cvt_pk_bf16_f32 v56, v84, v85
  v_cvt_pk_bf16_f32 v57, v86, v87
  v_cvt_pk_bf16_f32 v58, v88, v89
  v_cvt_pk_bf16_f32 v59, v90, v91
  v_lshlrev_b32 v84, 16, v56
  v_and_b32 v85, 0xffff0000, v56
  v_lshlrev_b32 v86, 16, v57
  v_and_b32 v87, 0xffff0000, v57
  v_lshlrev_b32 v88, 16, v58
  v_and_b32 v89, 0xffff0000, v58
  v_lshlrev_b32 v90, 16, v59
  v_and_b32 v91, 0xffff0000, v59
  v_mul_f32 v84, s77, v84
  v_mul_f32 v85, s77, v85
  v_mul_f32 v86, s77, v86
  v_mul_f32 v87, s77, v87
  v_mul_f32 v88, s77, v88
  v_mul_f32 v89, s77, v89
  v_mul_f32 v90, s77, v90
  v_mul_f32 v91, s77, v91
  v_cvt_pk_bf16_f32 v56, v84, v85
  v_cvt_pk_bf16_f32 v57, v86, v87
  v_cvt_pk_bf16_f32 v58, v88, v89
  v_cvt_pk_bf16_f32 v59, v90, v91
  v_lshlrev_b32 v84, 16, v56
  v_and_b32 v85, 0xffff0000, v56
  v_lshlrev_b32 v86, 16, v57
  v_and_b32 v87, 0xffff0000, v57
  v_lshlrev_b32 v88, 16, v58
  v_and_b32 v89, 0xffff0000, v58
  v_lshlrev_b32 v90, 16, v59
  v_and_b32 v91, 0xffff0000, v59
  v_max3_f32 v52, v84, v85, v86
  v_max3_f32 v53, v87, v88, v89
  v_max3_f32 v52, v52, v90, v91
  v_max_f32 v52, v52, v53
  v_mov_b32 v53, v52
  s_nop 1
  v_permlane32_swap_b32 v52, v53
  v_max_f32 v52, v52, v53
  v_mov_b32 v53, v52
  s_nop 1
  v_permlane16_swap_b32 v52, v53
  v_max_f32 v52, v52, v53
  v_cmp_gt_f32 vcc, v52, v24
  s_nop 0
  s_cbranch_vccz L_norescale_26
  v_max_f32 v52, v52, v24
  v_sub_f32 v53, v24, v52
  v_mul_f32 v53, s64, v53
  v_exp_f32 v53, v53
  v_mov_b32 v24, v52
  v_mul_f32 v26, s64, v52
  v_mul_f32 v25, v25, v53
  v_mul_f32 v160, v160, v53
  v_mul_f32 v161, v161, v53
  v_mul_f32 v162, v162, v53
  v_mul_f32 v163, v163, v53
  v_mul_f32 v164, v164, v53
  v_mul_f32 v165, v165, v53
  v_mul_f32 v166, v166, v53
  v_mul_f32 v167, v167, v53
  v_mul_f32 v168, v168, v53
  v_mul_f32 v169, v169, v53
  v_mul_f32 v170, v170, v53
  v_mul_f32 v171, v171, v53
  v_mul_f32 v172, v172, v53
  v_mul_f32 v173, v173, v53
  v_mul_f32 v174, v174, v53
  v_mul_f32 v175, v175, v53
  v_mul_f32 v176, v176, v53
  v_mul_f32 v177, v177, v53
  v_mul_f32 v178, v178, v53
  v_mul_f32 v179, v179, v53
  v_mul_f32 v180, v180, v53
  v_mul_f32 v181, v181, v53
  v_mul_f32 v182, v182, v53
  v_mul_f32 v183, v183, v53
  v_mul_f32 v184, v184, v53
  v_mul_f32 v185, v185, v53
  v_mul_f32 v186, v186, v53
  v_mul_f32 v187, v187, v53
  v_mul_f32 v188, v188, v53
  v_mul_f32 v189, v189, v53
  v_mul_f32 v190, v190, v53
  v_mul_f32 v191, v191, v53
L_norescale_26:
  v_fma_f32 v84, v84, s64, -v26
  v_fma_f32 v85, v85, s64, -v26
  v_fma_f32 v86, v86, s64, -v26
  v_fma_f32 v87, v87, s64, -v26
  v_fma_f32 v88, v88, s64, -v26
  v_fma_f32 v89, v89, s64, -v26
  v_fma_f32 v90, v90, s64, -v26
  v_fma_f32 v91, v91, s64, -v26
  v_exp_f32 v84, v84
  v_exp_f32 v85, v85
  v_exp_f32 v86, v86
  v_exp_f32 v87, v87
  v_exp_f32 v88, v88
  v_exp_f32 v89, v89
  v_exp_f32 v90, v90
  v_exp_f32 v91, v91
  v_add_f32 v52, v84, v85
  v_add_f32 v53, v86, v87
  v_cvt_pk_bf16_f32 v92, v84, v85
  v_cvt_pk_bf16_f32 v93, v86, v87
  v_cvt_pk_bf16_f32 v94, v88, v89
  v_cvt_pk_bf16_f32 v95, v90, v91
  v_add_f32 v52, v52, v88
  v_add_f32 v53, v53, v89
  v_add_f32 v52, v52, v90
  v_add_f32 v53, v53, v91
  v_add_f32 v52, v52, v53
  v_add_f32 v25, v25, v52
  s_branch L_finv0
L_dlast1:
  s_waitcnt vmcnt(8)
  ds_read_b128 v[96:99], v8 offset:16384
  ds_read_b128 v[112:115], v8 offset:20480
  ds_read_b128 v[100:103], v9 offset:16384
  ds_read_b128 v[116:119], v9 offset:20480
  ds_read_b128 v[104:107], v10 offset:16384
  ds_read_b128 v[120:123], v10 offset:20480
  ds_read_b128 v[108:111], v11 offset:16384
  ds_read_b128 v[124:127], v11 offset:20480
  s_waitcnt lgkmcnt(6)
  v_mfma_f32_16x16x32_bf16 v[84:87], v[96:99], v[68:71], 0
  v_mfma_f32_16x16x32_bf16 v[88:91], v[112:115], v[68:71], 0
  s_waitcnt lgkmcnt(4)
  v_mfma_f32_16x16x32_bf16 v[84:87], v[100:103], v[72:75], v[84:87]
  v_mfma_f32_16x16x32_bf16 v[88:91], v[116:119], v[72:75], v[88:91]
  s_waitcnt lgkmcnt(2)
  v_mfma_f32_16x16x32_bf16 v[84:87], v[104:107], v[76:79], v[84:87]
  v_mfma_f32_16x16x32_bf16 v[88:91], v[120:123], v[76:79], v[88:91]
  s_waitcnt lgkmcnt(0)
  v_mfma_f32_16x16x32_bf16 v[84:87], v[108:111], v[80:83], v[84:87]
  v_mfma_f32_16x16x32_bf16 v[88:91], v[124:127], v[80:83], v[88:91]
  s_nop 6
  v_cvt_pk_bf16_f32 v56, v84, v85
  v_cvt_pk_bf16_f32 v57, v86, v87
  v_cvt_pk_bf16_f32 v58, v88, v89
  v_cvt_pk_bf16_f32 v59, v90, v91
  v_lshlrev_b32 v84, 16, v56
  v_and_b32 v85, 0xffff0000, v56
  v_lshlrev_b32 v86, 16, v57
  v_and_b32 v87, 0xffff0000, v57
  v_lshlrev_b32 v88, 16, v58
  v_and_b32 v89, 0xffff0000, v58
  v_lshlrev_b32 v90, 16, v59
  v_and_b32 v91, 0xffff0000, v59
  v_mul_f32 v84, s77, v84
  v_mul_f32 v85, s77, v85
  v_mul_f32 v86, s77, v86
  v_mul_f32 v87, s77, v87
  v_mul_f32 v88, s77, v88
  v_mul_f32 v89, s77, v89
  v_mul_f32 v90, s77, v90
  v_mul_f32 v91, s77, v91
  v_cvt_pk_bf16_f32 v56, v84, v85
  v_cvt_pk_bf16_f32 v57, v86, v87
  v_cvt_pk_bf16_f32 v58, v88, v89
  v_cvt_pk_bf16_f32 v59, v90, v91
  v_lshlrev_b32 v84, 16, v56
  v_and_b32 v85, 0xffff0000, v56
  v_lshlrev_b32 v86, 16, v57
  v_and_b32 v87, 0xffff0000, v57
  v_lshlrev_b32 v88, 16, v58
  v_and_b32 v89, 0xffff0000, v58
  v_lshlrev_b32 v90, 16, v59
  v_and_b32 v91, 0xffff0000, v59
  v_max3_f32 v52, v84, v85, v86
  v_max3_f32 v53, v87, v88, v89
  v_max3_f32 v52, v52, v90, v91
  v_max_f32 v52, v52, v53
  v_mov_b32 v53, v52
  s_nop 1
  v_permlane32_swap_b32 v52, v53
  v_max_f32 v52, v52, v53
  v_mov_b32 v53, v52
  s_nop 1
  v_permlane16_swap_b32 v52, v53
  v_max_f32 v52, v52, v53
  v_cmp_gt_f32 vcc, v52, v24
  s_nop 0
  s_cbranch_vccz L_norescale_27
  v_max_f32 v52, v52, v24
  v_sub_f32 v53, v24, v52
  v_mul_f32 v53, s64, v53
  v_exp_f32 v53, v53
  v_mov_b32 v24, v52
  v_mul_f32 v26, s64, v52
  v_mul_f32 v25, v25, v53
  v_mul_f32 v160, v160, v53
  v_mul_f32 v161, v161, v53
  v_mul_f32 v162, v162, v53
  v_mul_f32 v163, v163, v53
  v_mul_f32 v164, v164, v53
  v_mul_f32 v165, v165, v53
  v_mul_f32 v166, v166, v53
  v_mul_f32 v167, v167, v53
  v_mul_f32 v168, v168, v53
  v_mul_f32 v169, v169, v53
  v_mul_f32 v170, v170, v53
  v_mul_f32 v171, v171, v53
  v_mul_f32 v172, v172, v53
  v_mul_f32 v173, v173, v53
  v_mul_f32 v174, v174, v53
  v_mul_f32 v175, v175, v53
  v_mul_f32 v176, v176, v53
  v_mul_f32 v177, v177, v53
  v_mul_f32 v178, v178, v53
  v_mul_f32 v179, v179, v53
  v_mul_f32 v180, v180, v53
  v_mul_f32 v181, v181, v53
  v_mul_f32 v182, v182, v53
  v_mul_f32 v183, v183, v53
  v_mul_f32 v184, v184, v53
  v_mul_f32 v185, v185, v53
  v_mul_f32 v186, v186, v53
  v_mul_f32 v187, v187, v53
  v_mul_f32 v188, v188, v53
  v_mul_f32 v189, v189, v53
  v_mul_f32 v190, v190, v53
  v_mul_f32 v191, v191, v53
L_norescale_27:
  v_fma_f32 v84, v84, s64, -v26
  v_fma_f32 v85, v85, s64, -v26
  v_fma_f32 v86, v86, s64, -v26
  v_fma_f32 v87, v87, s64, -v26
  v_fma_f32 v88, v88, s64, -v26
  v_fma_f32 v89, v89, s64, -v26
  v_fma_f32 v90, v90, s64, -v26
  v_fma_f32 v91, v91, s64, -v26
  v_exp_f32 v84, v84
  v_exp_f32 v85, v85
  v_exp_f32 v86, v86
  v_exp_f32 v87, v87
  v_exp_f32 v88, v88
  v_exp_f32 v89, v89
  v_exp_f32 v90, v90
  v_exp_f32 v91, v91
  v_add_f32 v52, v84, v85
  v_add_f32 v53, v86, v87
  v_cvt_pk_bf16_f32 v92, v84, v85
  v_cvt_pk_bf16_f32 v93, v86, v87
  v_cvt_pk_bf16_f32 v94, v88, v89
  v_cvt_pk_bf16_f32 v95, v90, v91
  v_add_f32 v52, v52, v88
  v_add_f32 v53, v53, v89
  v_add_f32 v52, v52, v90
  v_add_f32 v53, v53, v91
  v_add_f32 v52, v52, v53
  v_add_f32 v25, v25, v52
  s_branch L_finv1
L_finv0:
  s_waitcnt vmcnt(0)
  ds_read_b64_tr_b16 v[128:129], v12 offset:8192
  ds_read_b64_tr_b16 v[130:131], v12 offset:12288
  ds_read_b64_tr_b16 v[132:133], v13 offset:8192
  ds_read_b64_tr_b16 v[134:135], v13 offset:12288
  ds_read_b64_tr_b16 v[136:137], v14 offset:8192
  ds_read_b64_tr_b16 v[138:139], v14 offset:12288
  ds_read_b64_tr_b16 v[140:141], v15 offset:8192
  ds_read_b64_tr_b16 v[142:143], v15 offset:12288
  ds_read_b64_tr_b16 v[144:145], v16 offset:8192
  ds_read_b64_tr_b16 v[146:147], v16 offset:12288
  ds_read_b64_tr_b16 v[148:149], v17 offset:8192
  ds_read_b64_tr_b16 v[150:151], v17 offset:12288
  ds_read_b64_tr_b16 v[152:153], v18 offset:8192
  ds_read_b64_tr_b16 v[154:155], v18 offset:12288
  s_waitcnt lgkmcnt(12)
  v_mfma_f32_16x16x32_bf16 v[160:163], v[128:131], v[92:95], v[160:163]
  ds_read_b64_tr_b16 v[156:157], v19 offset:8192
  ds_read_b64_tr_b16 v[158:159], v19 offset:12288
  s_waitcnt lgkmcnt(12)
  v_mfma_f32_16x16x32_bf16 v[164:167], v[132:135], v[92:95], v[164:167]
  s_waitcnt lgkmcnt(10)
  v_mfma_f32_16x16x32_bf16 v[168:171], v[136:139], v[92:95], v[168:171]
  s_waitcnt lgkmcnt(8)
  v_mfma_f32_16x16x32_bf16 v[172:175], v[140:143], v[92:95], v[172:175]
  s_waitcnt lgkmcnt(6)
  v_mfma_f32_16x16x32_bf16 v[176:179], v[144:147], v[92:95], v[176:179]
  s_waitcnt lgkmcnt(4)
  v_mfma_f32_16x16x32_bf16 v[180:183], v[148:151], v[92:95], v[180:183]
  s_waitcnt lgkmcnt(2)
  v_mfma_f32_16x16x32_bf16 v[184:187], v[152:155], v[92:95], v[184:187]
  s_waitcnt lgkmcnt(0)
  v_mfma_f32_16x16x32_bf16 v[188:191], v[156:159], v[92:95], v[188:191]
  s_branch L_tail
L_finv1:
  s_waitcnt vmcnt(0)
  ds_read_b64_tr_b16 v[128:129], v12 offset:24576
  ds_read_b64_tr_b16 v[130:131], v12 offset:28672
  ds_read_b64_tr_b16 v[132:133], v13 offset:24576
  ds_read_b64_tr_b16 v[134:135], v13 offset:28672
  ds_read_b64_tr_b16 v[136:137], v14 offset:24576
  ds_read_b64_tr_b16 v[138:139], v14 offset:28672
  ds_read_b64_tr_b16 v[140:141], v15 offset:24576
  ds_read_b64_tr_b16 v[142:143], v15 offset:28672
  ds_read_b64_tr_b16 v[144:145], v16 offset:24576
  ds_read_b64_tr_b16 v[146:147], v16 offset:28672
  ds_read_b64_tr_b16 v[148:149], v17 offset:24576
  ds_read_b64_tr_b16 v[150:151], v17 offset:28672
  ds_read_b64_tr_b16 v[152:153], v18 offset:24576
  ds_read_b64_tr_b16 v[154:155], v18 offset:28672
  s_waitcnt lgkmcnt(12)
  v_mfma_f32_16x16x32_bf16 v[160:163], v[128:131], v[92:95], v[160:163]
  ds_read_b64_tr_b16 v[156:157], v19 offset:24576
  ds_read_b64_tr_b16 v[158:159], v19 offset:28672
  s_waitcnt lgkmcnt(12)
  v_mfma_f32_16x16x32_bf16 v[164:167], v[132:135], v[92:95], v[164:167]
  s_waitcnt lgkmcnt(10)
  v_mfma_f32_16x16x32_bf16 v[168:171], v[136:139], v[92:95], v[168:171]
  s_waitcnt lgkmcnt(8)
  v_mfma_f32_16x16x32_bf16 v[172:175], v[140:143], v[92:95], v[172:175]
  s_waitcnt lgkmcnt(6)
  v_mfma_f32_16x16x32_bf16 v[176:179], v[144:147], v[92:95], v[176:179]
  s_waitcnt lgkmcnt(4)
  v_mfma_f32_16x16x32_bf16 v[180:183], v[148:151], v[92:95], v[180:183]
  s_waitcnt lgkmcnt(2)
  v_mfma_f32_16x16x32_bf16 v[184:187], v[152:155], v[92:95], v[184:187]
  s_waitcnt lgkmcnt(0)
  v_mfma_f32_16x16x32_bf16 v[188:191], v[156:159], v[92:95], v[188:191]
L_tail:
  s_mov_b32 exec_lo, 0x000f000f
  s_mov_b32 exec_hi, 0x000f000f
  ds_write_b128 v35, v[160:163] offset:0
  ds_write_b128 v35, v[164:167] offset:64
  ds_write_b128 v35, v[168:171] offset:128
  ds_write_b128 v35, v[172:175] offset:192
  ds_write_b128 v35, v[176:179] offset:256
  ds_write_b128 v35, v[180:183] offset:320
  ds_write_b128 v35, v[184:187] offset:384
  ds_write_b128 v35, v[188:191] offset:448
  s_mov_b64 exec, -1
  v_mov_b32 v54, v24
  v_mov_b32 v52, v25
  s_nop 1
  v_permlane32_swap_b32 v25, v52
  v_add_f32 v25, v25, v52
  v_mov_b32 v52, v25
  s_nop 1
  v_permlane16_swap_b32 v25, v52
  v_add_f32 v25, v25, v52
  v_mov_b32 v55, v25
  s_mov_b32 exec_lo, 0x000f000f
  s_mov_b32 exec_hi, 0x000f000f
  ds_write_b64 v36, v[54:55]
  s_mov_b64 exec, -1
  s_waitcnt lgkmcnt(0)
  s_barrier
  ds_read_b64 v[224:225], v38 offset:0
  ds_read_b64 v[226:227], v38 offset:32
  ds_read_b64 v[228:229], v38 offset:64
  ds_read_b64 v[230:231], v38 offset:96
  ds_read_b128 v[208:211], v37 offset:0
  ds_read_b128 v[212:215], v37 offset:2112
  ds_read_b128 v[216:219], v37 offset:4224
  ds_read_b128 v[220:223], v37 offset:6336
  s_waitcnt lgkmcnt(4)
  v_max3_f32 v56, v224, v226, v228
  v_max_f32 v56, v56, v230
  v_and_b32 v56, v21, v56
  v_sub_f32 v224, v224, v56
  v_sub_f32 v226, v226, v56
  v_sub_f32 v228, v228, v56
  v_sub_f32 v230, v230, v56
  v_mul_f32 v224, s64, v224
  v_mul_f32 v226, s64, v226
  v_mul_f32 v228, s64, v228
  v_mul_f32 v230, s64, v230
  v_exp_f32 v224, v224
  v_exp_f32 v226, v226
  v_exp_f32 v228, v228
  v_exp_f32 v230, v230
  v_or_b32 v56, v56, v20
  v_mov_b32 v58, v20
  v_mov_b32 v59, v20
  v_mul_f32 v57, v224, v225
  s_waitcnt lgkmcnt(0)
  v_mul_f32 v208, v224, v208
  v_mul_f32 v209, v224, v209
  v_mul_f32 v210, v224, v210
  v_mul_f32 v211, v224, v211
  v_fmac_f32 v57, v226, v227
  v_fmac_f32 v208, v226, v212
  v_fmac_f32 v209, v226, v213
  v_fmac_f32 v210, v226, v214
  v_fmac_f32 v211, v226, v215
  v_fmac_f32 v57, v228, v229
  v_fmac_f32 v208, v228, v216
  v_fmac_f32 v209, v228, v217
  v_fmac_f32 v210, v228, v218
  v_fmac_f32 v211, v228, v219
  v_fmac_f32 v57, v230, v231
  v_fmac_f32 v208, v230, v220
  v_fmac_f32 v209, v230, v221
  v_fmac_f32 v210, v230, v222
  v_fmac_f32 v211, v230, v223
  v_bfi_b32 v208, v21, v208, v20
  v_bfi_b32 v209, v21, v209, v20
  v_bfi_b32 v210, v21, v210, v20
  v_bfi_b32 v211, v21, v211, v20
  v_bfi_b32 v57, v21, v57, v20
  s_mov_b32 exec_hi, 0
  buffer_store_dwordx4 v[208:211], v39, s[12:15], s69 offen sc1
  s_mov_b64 exec, 0xff
  buffer_store_dwordx4 v[56:59], v34, s[12:15], s70 offen sc1
  s_mov_b64 exec, -1
  ds_read_b64_tr_b16 v[192:193], v45 offset:0
  ds_read_b64_tr_b16 v[194:195], v45 offset:4096
  ds_read_b64_tr_b16 v[196:197], v45 offset:8192
  ds_read_b64_tr_b16 v[198:199], v45 offset:12288
  ds_read_b64_tr_b16 v[200:201], v46 offset:0
  ds_read_b64_tr_b16 v[202:203], v46 offset:4096
  ds_read_b64_tr_b16 v[204:205], v46 offset:8192
  ds_read_b64_tr_b16 v[206:207], v46 offset:12288
  s_cmp_ge_u32 s74, 32
  s_cbranch_scc1 L_nofin_28
  s_cmp_lg_u32 s3, 0
  s_cbranch_scc1 L_nofin_28
  s_mov_b32 s16, s24
  s_and_b32 s17, s25, 0xffff
  s_mov_b32 s18, 2048
  s_mov_b32 s19, 0x20000
  s_mov_b32 s20, s42
  s_and_b32 s21, s43, 0xffff
  s_mov_b32 s22, 1024
  s_mov_b32 s23, 0x20000
  s_lshl_b32 s58, s74, 6
  v_lshlrev_b32 v52, 1, v44
  buffer_load_ushort v48, v52, s[16:19], s58 offen
  s_and_b32 s59, s58, 1023
  buffer_load_ushort v49, v52, s[20:23], s59 offen
  s_lshl_b32 s58, s74, 12
  s_add_u32 s58, s58, 196608
  buffer_load_dwordx4 v[128:131], v34, s[12:15], s58 offen offset:0 sc1
  buffer_load_dwordx4 v[132:135], v34, s[12:15], s58 offen offset:1024 sc1
  buffer_load_dwordx4 v[136:139], v34, s[12:15], s58 offen offset:2048 sc1
  buffer_load_dwordx4 v[140:143], v34, s[12:15], s58 offen offset:3072 sc1
L_nofin_28:
  s_mov_b32 s65, 400000
L_h1_retry_29:
  buffer_load_dwordx4 v[216:219], v40, s[12:15], s72 offen sc1
  buffer_load_dwordx4 v[220:223], v40, s[12:15], s72 offen offset:1024 sc1
  buffer_load_dwordx4 v[208:211], v34, s[12:15], s71 offen sc1
  buffer_load_dwordx4 v[212:215], v34, s[12:15], s71 offen offset:1024 sc1
  s_waitcnt vmcnt(0)
  v_xor_b32 v54, v216, v20
  v_xor_b32 v55, v217, v20
  v_xor_b32 v56, v218, v20
  v_or3_b32 v54, v54, v55, v56
  v_xor_b32 v55, v219, v20
  v_xor_b32 v56, v220, v20
  v_or3_b32 v54, v54, v55, v56
  v_xor_b32 v55, v221, v20
  v_xor_b32 v56, v222, v20
  v_or3_b32 v54, v54, v55, v56
  v_xor_b32 v55, v223, v20
  v_xor_b32 v56, v208, v20
  v_or3_b32 v54, v54, v55, v56
  v_xor_b32 v55, v209, v20
  v_xor_b32 v56, v210, v20
  v_or3_b32 v54, v54, v55, v56
  v_xor_b32 v55, v211, v20
  v_xor_b32 v56, v212, v20
  v_or3_b32 v54, v54, v55, v56
  v_xor_b32 v55, v213, v20
  v_xor_b32 v56, v214, v20
  v_or3_b32 v54, v54, v55, v56
  v_xor_b32 v55, v215, v20
  v_or_b32 v54, v54, v55
  v_and_b32 v54, 1023, v54
  v_cmp_ne_u32 vcc, 0, v54
  s_nop 0
  s_cbranch_vccnz L_h1_fail_30
  s_branch L_h1_ok_31
L_h1_fail_30:
  s_sub_u32 s65, s65, 1
  s_cmp_lg_u32 s65, 0
  s_cbranch_scc1 L_h1_retry_29
  s_or_b32 s67, s67, 2
L_h1_ok_31:
  v_and_b32 v216, v21, v216
  v_and_b32 v220, v21, v220
  v_and_b32 v217, v21, v217
  v_and_b32 v221, v21, v221
  v_and_b32 v208, v21, v208
  v_and_b32 v209, v21, v209
  v_and_b32 v210, v21, v210
  v_and_b32 v211, v21, v211
  v_and_b32 v212, v21, v212
  v_and_b32 v213, v21, v213
  v_and_b32 v214, v21, v214
  v_and_b32 v215, v21, v215
  v_max_f32 v54, v216, v220
  s_nop 1
  v_max_f32 v54, v54, v54 row_ror:8 row_mask:0xf bank_mask:0xf
  v_mov_b32 v55, v54
  s_nop 1
  v_permlane16_swap_b32 v54, v55
  v_max_f32 v54, v54, v55
  v_mov_b32 v55, v54
  s_nop 1
  v_permlane32_swap_b32 v54, v55
  v_max_f32 v54, v54, v55
  v_sub_f32 v216, v216, v54
  v_sub_f32 v220, v220, v54
  v_mul_f32 v216, s64, v216
  v_mul_f32 v220, s64, v220
  v_exp_f32 v216, v216
  v_exp_f32 v220, v220
  v_mul_f32 v56, v216, v217
  v_mul_f32 v208, v216, v208
  v_mul_f32 v209, v216, v209
  v_mul_f32 v210, v216, v210
  v_mul_f32 v211, v216, v211
  v_fmac_f32 v56, v220, v221
  v_fmac_f32 v208, v220, v212
  v_fmac_f32 v209, v220, v213
  v_fmac_f32 v210, v220, v214
  v_fmac_f32 v211, v220, v215
  v_add_f32 v56, v56, v56 row_ror:8 row_mask:0xf bank_mask:0xf
  v_permlane32_swap_b32 v208, v210
  v_permlane32_swap_b32 v209, v211
  v_mov_b32 v55, v56
  v_add_f32 v208, v208, v210
  v_add_f32 v209, v209, v211
  v_permlane16_swap_b32 v56, v55
  s_nop 0
  v_permlane16_swap_b32 v208, v209
  v_add_f32 v56, v56, v55
  v_add_f32 v208, v208, v209
  v_mov_b32 v55, v56
  s_nop 0
  v_add_f32 v208, v208, v208 row_ror:8 row_mask:0xf bank_mask:0xf
  v_permlane32_swap_b32 v56, v55
  v_add_f32 v56, v56, v55
  v_rcp_f32 v56, v56
  s_nop 0
  v_mul_f32 v208, v208, v56
  v_cvt_pk_bf16_f32 v208, v208, v208
  ds_write_b16 v41, v208
  s_waitcnt lgkmcnt(0)
  s_barrier
  ds_read_b64 v[68:69], v42 offset:0
  ds_read_b64 v[70:71], v42 offset:32
  ds_read_b64 v[72:73], v42 offset:64
  ds_read_b64 v[74:75], v42 offset:96
  v_and_b32 v53, 2, v1
  v_cmp_ne_u32 vcc, 0, v53
  s_waitcnt lgkmcnt(2)
  v_mfma_f32_16x16x32_bf16 v[84:87], v[192:195], v[68:71], 0
  v_mfma_f32_16x16x32_bf16 v[88:91], v[200:203], v[68:71], 0
  s_waitcnt lgkmcnt(0)
  v_mfma_f32_16x16x32_bf16 v[84:87], v[196:199], v[72:75], v[84:87]
  v_mfma_f32_16x16x32_bf16 v[88:91], v[204:207], v[72:75], v[88:91]
  s_nop 7
  v_cndmask_b32 v56, v84, v88, vcc
  v_cndmask_b32 v57, v85, v89, vcc
  v_cndmask_b32 v58, v86, v90, vcc
  v_cndmask_b32 v59, v87, v91, vcc
  v_bfi_b32 v56, v21, v56, v20
  v_bfi_b32 v57, v21, v57, v20
  v_bfi_b32 v58, v21, v58, v20
  v_bfi_b32 v59, v21, v59, v20
  s_mov_b32 exec_lo, 0x000f000f
  s_mov_b32 exec_hi, 0x000f000f
  buffer_store_dwordx4 v[56:59], v43, s[12:15], s73 offen sc1
  s_mov_b64 exec, -1
  s_cmp_ge_u32 s74, 32
  s_cbranch_scc1 L_done_32
  s_lshl_b32 s60, s74, 13
  s_lshl_b32 s58, s3, 11
  s_add_u32 s60, s60, s58
  s_add_u32 s60, s60, 1048576
  buffer_load_dwordx4 v[96:99], v34, s[12:15], s60 offen offset:0 sc1
  buffer_load_dwordx4 v[100:103], v34, s[12:15], s60 offen offset:1024 sc1
  s_lshl_b32 s58, s3, 7
  s_add_u32 s58, s58, 147456
  v_lshlrev_b32 v61, 2, v44
  v_add_u32 v62, 147456, v61
  v_add_u32 v61, s58, v61
  s_cmp_lg_u32 s3, 0
  s_cbranch_scc1 L_nogate_33
  s_lshl_b32 s58, s74, 12
  s_add_u32 s58, s58, 196608
  s_mov_b32 s65, 400000
L_yretry_35:
  v_cmp_gt_u32 vcc, 32, v1
  s_nop 1
  v_cndmask_b32 v140, v20, v140, vcc
  v_cndmask_b32 v141, v20, v141, vcc
  v_cndmask_b32 v142, v20, v142, vcc
  v_cndmask_b32 v143, v20, v143, vcc
  v_xor_b32 v54, v128, v20
  v_xor_b32 v55, v129, v20
  v_xor_b32 v56, v130, v20
  v_or3_b32 v54, v54, v55, v56
  v_xor_b32 v55, v131, v20
  v_xor_b32 v56, v132, v20
  v_or3_b32 v54, v54, v55, v56
  v_xor_b32 v55, v133, v20
  v_xor_b32 v56, v134, v20
  v_or3_b32 v54, v54, v55, v56
  v_xor_b32 v55, v135, v20
  v_xor_b32 v56, v136, v20
  v_or3_b32 v54, v54, v55, v56
  v_xor_b32 v55, v137, v20
  v_xor_b32 v56, v138, v20
  v_or3_b32 v54, v54, v55, v56
  v_xor_b32 v55, v139, v20
  v_xor_b32 v56, v140, v20
  v_or3_b32 v54, v54, v55, v56
  v_xor_b32 v55, v141, v20
  v_xor_b32 v56, v142, v20
  v_or3_b32 v54, v54, v55, v56
  v_xor_b32 v55, v143, v20
  v_or_b32 v54, v54, v55
  v_and_b32 v54, 1023, v54
  v_cmp_ne_u32 vcc, 0, v54
  s_nop 0
  s_cbranch_vccnz L_yfl_36
  s_branch L_yok_34
L_yfl_36:
  buffer_load_dwordx4 v[128:131], v34, s[12:15], s58 offen offset:0 sc1
  buffer_load_dwordx4 v[132:135], v34, s[12:15], s58 offen offset:1024 sc1
  buffer_load_dwordx4 v[136:139], v34, s[12:15], s58 offen offset:2048 sc1
  buffer_load_dwordx4 v[140:143], v34, s[12:15], s58 offen offset:3072 sc1
  s_waitcnt vmcnt(0)
  s_sub_u32 s65, s65, 1
  s_cmp_lg_u32 s65, 0
  s_cbranch_scc1 L_yretry_35
  s_or_b32 s67, s67, 4
L_yok_34:
  v_and_b32 v128, v21, v128
  v_and_b32 v129, v21, v129
  v_and_b32 v130, v21, v130
  v_and_b32 v131, v21, v131
  v_and_b32 v132, v21, v132
  v_and_b32 v133, v21, v133
  v_and_b32 v134, v21, v134
  v_and_b32 v135, v21, v135
  v_and_b32 v136, v21, v136
  v_and_b32 v137, v21, v137
  v_and_b32 v138, v21, v138
  v_and_b32 v139, v21, v139
  v_and_b32 v140, v21, v140
  v_and_b32 v141, v21, v141
  v_and_b32 v142, v21, v142
  v_and_b32 v143, v21, v143
  v_add_f32 v128, v128, v132
  v_add_f32 v136, v136, v140
  v_add_f32 v129, v129, v133
  v_add_f32 v137, v137, v141
  v_add_f32 v130, v130, v134
  v_add_f32 v138, v138, v142
  v_add_f32 v131, v131, v135
  v_add_f32 v139, v139, v143
  v_add_f32 v128, v128, v136
  v_add_f32 v129, v129, v137
  v_add_f32 v130, v130, v138
  v_add_f32 v131, v131, v139
  s_nop 0
  v_permlane32_swap_b32 v128, v130
  v_permlane32_swap_b32 v129, v131
  v_add_f32 v128, v128, v130
  v_add_f32 v129, v129, v131
  s_nop 1
  v_permlane16_swap_b32 v128, v129
  v_add_f32 v128, v128, v129
  s_nop 1
  v_add_f32 v128, v128, v128 row_ror:8 row_mask:0xf bank_mask:0xf
  v_cvt_pk_bf16_f32 v128, v128, v128
  v_and_b32 v128, 0xffff0000, v128
  v_lshlrev_b32 v49, 16, v49
  v_add_f32 v128, v128, v49
  v_cvt_pk_bf16_f32 v128, v128, v128
  v_and_b32 v128, 0xffff0000, v128
  v_mul_f32 v54, 0xbfb8aa3b, v128
  v_exp_f32 v54, v54
  s_nop 0
  v_add_f32 v54, 1.0, v54
  v_rcp_f32 v54, v54
  s_nop 0
  v_mul_f32 v50, v128, v54
  v_cvt_pk_bf16_f32 v50, v50, v50
  v_and_b32 v50, 0xffff0000, v50
  v_lshlrev_b32 v48, 16, v48
  s_mov_b32 s16, s44
  s_and_b32 s17, s45, 0xffff
  s_mov_b32 s18, 2048
  s_mov_b32 s19, 0x20000
  v_lshlrev_b32 v60, 1, v44
L_nogate_33:
  s_mov_b32 s65, 400000
L_sretry_39:
  s_waitcnt vmcnt(0)
  v_xor_b32 v54, v96, v20
  v_xor_b32 v55, v97, v20
  v_xor_b32 v56, v98, v20
  v_or3_b32 v54, v54, v55, v56
  v_xor_b32 v55, v99, v20
  v_xor_b32 v56, v100, v20
  v_or3_b32 v54, v54, v55, v56
  v_xor_b32 v55, v101, v20
  v_xor_b32 v56, v102, v20
  v_or3_b32 v54, v54, v55, v56
  v_xor_b32 v55, v103, v20
  v_or_b32 v54, v54, v55
  v_and_b32 v54, 1023, v54
  v_cmp_ne_u32 vcc, 0, v54
  s_nop 0
  s_cbranch_vccnz L_sfl_38
  s_branch L_sok_37
L_sfl_38:
  buffer_load_dwordx4 v[96:99], v34, s[12:15], s60 offen offset:0 sc1
  buffer_load_dwordx4 v[100:103], v34, s[12:15], s60 offen offset:1024 sc1
  s_sub_u32 s65, s65, 1
  s_cmp_lg_u32 s65, 0
  s_cbranch_scc1 L_sretry_39
  s_or_b32 s67, s67, 8
  s_waitcnt vmcnt(0)
L_sok_37:
  v_and_b32 v96, v21, v96
  v_and_b32 v97, v21, v97
  v_and_b32 v98, v21, v98
  v_and_b32 v99, v21, v99
  v_and_b32 v100, v21, v100
  v_and_b32 v101, v21, v101
  v_and_b32 v102, v21, v102
  v_and_b32 v103, v21, v103
  v_add_f32 v96, v96, v100
  v_add_f32 v97, v97, v101
  v_add_f32 v98, v98, v102
  v_add_f32 v99, v99, v103
  s_nop 0
  v_permlane32_swap_b32 v96, v98
  v_permlane32_swap_b32 v97, v99
  v_add_f32 v96, v96, v98
  v_add_f32 v97, v97, v99
  s_nop 1
  v_permlane16_swap_b32 v96, v97
  v_add_f32 v96, v96, v97
  s_nop 1
  v_add_f32 v96, v96, v96 row_ror:8 row_mask:0xf bank_mask:0xf
  ds_write_b32 v61, v96
  s_waitcnt lgkmcnt(0)
  s_barrier
  s_cmp_lg_u32 s3, 0
  s_cbranch_scc1 L_s4done_40
  ds_read_b32 v96, v62 offset:0
  ds_read_b32 v97, v62 offset:128
  ds_read_b32 v98, v62 offset:256
  ds_read_b32 v99, v62 offset:384
  s_lshl_b32 s58, s74, 6
  s_waitcnt lgkmcnt(0)
  v_add_f32 v96, v96, v97
  v_add_f32 v98, v98, v99
  v_add_f32 v96, v96, v98
  v_cvt_pk_bf16_f32 v96, v96, v96
  v_and_b32 v96, 0xffff0000, v96
  v_mul_f32 v96, v96, v50
  v_cvt_pk_bf16_f32 v96, v96, v96
  v_and_b32 v96, 0xffff0000, v96
  v_add_f32 v96, v96, v48
  v_cvt_pk_bf16_f32 v96, v96, v96
  s_mov_b32 exec_lo, 0x00ff00ff
  s_mov_b32 exec_hi, 0x00ff00ff
  buffer_store_short v96, v60, s[16:19], s58 offen
  s_mov_b64 exec, -1
L_s4done_40:
  s_or_b32 s58, s74, s3
  s_cmp_lg_u32 s58, 0
  s_cbranch_scc1 L_noep_41
  s_mov_b64 exec, 1
  buffer_store_dword v20, v23, s[12:15], 0 offen sc1
  s_mov_b64 exec, -1
L_noep_41:
L_done_32:
  s_cmp_eq_u32 s67, 0
  s_cbranch_scc1 L_noerr_42
  s_mov_b32 s16, s46
  s_and_b32 s17, s47, 0xffff
  s_mov_b32 s18, 256
  s_mov_b32 s19, 0x20000
  v_mov_b32 v52, s67
  s_mov_b64 exec, 1
  buffer_atomic_or v52, v23, s[16:19], 0 offen
L_noerr_42:
L_end:
  s_endpgm
L_codeend:
  s_endpgm
.section .rodata,"a"
.p2align 6
.amdhsa_kernel recurrent_scan__gqa_block_cached__dense_activation_gelu__decode_kernel
  .amdhsa_next_free_vgpr 240
  .amdhsa_next_free_sgpr 82
  .amdhsa_accum_offset 240
  .amdhsa_group_segment_fixed_size 0
  .amdhsa_kernarg_size 104
  .amdhsa_user_sgpr_count 2
  .amdhsa_user_sgpr_kernarg_segment_ptr 1
  .amdhsa_system_sgpr_workgroup_id_x 1
  .amdhsa_float_denorm_mode_32 3
.end_amdhsa_kernel
```
